```python
import torch

def _softmax(x, axis=-1):
    return torch.softmax(x, dim=axis)
def _gelu(x):
    return torch.nn.functional.gelu(x, approximate="tanh")
def _silu(x):
    return torch.nn.functional.silu(x)
def _sigmoid(x):
    return torch.sigmoid(x)
def _layernorm(x, axis=-1, eps=1e-5):
    m = x.mean(dim=axis, keepdim=True)
    v = x.var(dim=axis, keepdim=True, unbiased=False)
    return (x - m) / torch.sqrt(v + eps)
def _scatter_add(tgt, idx, src, axis=0):
    return tgt.clone().index_add_(axis, idx, src)
def _segment_sum(src, seg, n):
    out = torch.zeros((n,) + src.shape[1:], dtype=src.dtype)
    return out.index_add_(0, seg, src)
def _pad(x, pw):
    flat = tuple(v for pair in reversed(pw) for v in pair)
    return torch.nn.functional.pad(x, flat)

kernel_name = 'recurrent_scan__sliding_block_cached__dense_activation_gelu__decode'

def setup_inputs():

    _w = (lambda a: (lambda t: t.to(torch.bfloat16) if t.is_floating_point() else t)(torch.as_tensor(a)))
    def _A_setup():
        B, Sq, D = 8, 1, 1024
        Hq, Hkv, Sk, Dh = 32, 4, 4096, 128
        assert Hq % Hkv == 0, (Hq, Hkv)
        return {
            "x": _w((lambda *s: torch.randn(*s, dtype=torch.bfloat16) * 0.05)(B, Sq, D)),
            "k_cache": _w((lambda *s: torch.randn(*s, dtype=torch.bfloat16) * 3.2)(B, Hkv, Sk, Dh)),
            "v_cache": _w((lambda *s: torch.randn(*s, dtype=torch.bfloat16) * 3.2)(B, Hkv, Sk, Dh)),
            "wq": _w((lambda *s: torch.randn(*s, dtype=torch.bfloat16) * 3.2)(D, Hq * Dh) * (D ** -0.5)),
            "wo": _w((lambda *s: torch.randn(*s, dtype=torch.bfloat16) * 3.2)(Hq * Dh, D) * ((Hq * Dh) ** -0.5)),
        }
    _A_in = _A_setup()

    def _B_setup():
        B, S, D, F = 8, 1, 1024, 3584
        return {
            "x": _w((lambda *s: torch.randn(*s, dtype=torch.bfloat16) * 0.05)(B, S, D)),
            "w1": _w((lambda *s: torch.randn(*s, dtype=torch.bfloat16) * 3.2)(D, F) * (D ** -0.5)),
            "b1": _w((lambda *s: torch.randn(*s, dtype=torch.bfloat16) * 3.2)(F) * 0.01),
            "w2": _w((lambda *s: torch.randn(*s, dtype=torch.bfloat16) * 0.8)(F, D) * (F ** -0.5)),
            "b2": _w((lambda *s: torch.randn(*s, dtype=torch.bfloat16) * 0.8)(D) * 0.01),
        }
    _B_in = _B_setup()

    return {
        "A_x": _A_in["x"],
        "A_k_cache": _A_in["k_cache"],
        "A_v_cache": _A_in["v_cache"],
        "A_wq": _A_in["wq"],
        "A_wo": _A_in["wo"],
        "B_x": _B_in["x"],
        "B_w1": _B_in["w1"],
        "B_b1": _B_in["b1"],
        "B_w2": _B_in["w2"],
        "B_b2": _B_in["b2"],
    }

def reference(A_x, A_k_cache, A_v_cache, A_wq, A_wo, B_x, B_w1, B_b1, B_w2, B_b2):
    def _A_ref(x, k_cache, v_cache, wq, wo):
        B, Sq, D = x.shape
        Hq, Dh = 32, 128
        Hkv, Sk = k_cache.shape[1], k_cache.shape[2]
        W = min(4096, max(256, Sk // 4))
        rep = Hq // Hkv
        q = (lambda x, *d: x.permute(*d))((x @ wq).reshape(B, Sq, Hq, Dh), 0, 2, 1, 3)
        k = (lambda x, n, axis: torch.repeat_interleave(x, n, dim=axis))(k_cache[:, :, Sk - W:, :], rep, axis=1)
        v = (lambda x, n, axis: torch.repeat_interleave(x, n, dim=axis))(v_cache[:, :, Sk - W:, :], rep, axis=1)
        scores = torch.einsum("bhqd,bhkd->bhqk", q, k) * (Dh ** -0.5)
        p = _softmax(scores, axis=-1)
        o = torch.einsum("bhqk,bhkd->bhqd", p, v)
        return (lambda x, *d: x.permute(*d))(o, 0, 2, 1, 3).reshape(B, Sq, Hq * Dh) @ wo

    def _B_ref(x, w1, b1, w2, b2):
        h = torch.einsum("bsd,df->bsf", x, w1) + b1
        h = _gelu(h)
        return torch.einsum("bsf,fd->bsd", h, w2) + b2

    x = A_x
    xn = _layernorm(x, axis=-1)
    s = _A_ref(xn, A_k_cache, A_v_cache, A_wq, A_wo)
    g = _silu(_B_ref(xn, B_w1, B_b1, B_w2, B_b2))
    return x + s * g
```

```asm
; @launch grid=(256,1,1) block=(576,1,1) lds=147456
.amdgcn_target "amdgcn-amd-amdhsa--gfx950"
.text
.globl recurrent_scan__sliding_block_cached__dense_activation_gelu__decode_kernel
.p2align 8
.type recurrent_scan__sliding_block_cached__dense_activation_gelu__decode_kernel,@function
recurrent_scan__sliding_block_cached__dense_activation_gelu__decode_kernel:
    s_cmp_ge_u32 s2, 256
    s_cbranch_scc1 L_end
    s_load_dwordx16 s[8:23], s[0:1], 0
    s_load_dwordx8 s[24:31], s[0:1], 64
    s_load_dwordx2 s[32:33], s[0:1], 96
    v_and_b32 v1, 63, v0
    v_lshrrev_b32 v4, 6, v0
    s_nop 0
    v_readfirstlane_b32 s3, v4
    v_mov_b32 v10, 0
    s_and_b32 s4, s2, 7
    s_lshr_b32 s5, s2, 3
    s_lshl_b32 s47, s4, 2
    s_lshr_b32 s6, s5, 3
    s_add_u32 s47, s47, s6
    s_and_b32 s48, s5, 7
    s_and_b32 s49, s5, 3
    s_mov_b32 s37, 300000
    s_cmp_lt_u32 s5, 28
    s_cselect_b32 s39, 0, -32
    s_lshr_b32 s60, s5, 2
    s_lshl_b32 s61, s4, 3
    s_add_u32 s61, s61, s60
    s_mul_i32 s62, s4, 7
    s_add_u32 s62, s62, s60
    s_xor_b32 s61, s61, 4
    s_add_u32 s59, s48, s47
    s_and_b32 s59, s59, 7
    s_cmp_lg_u32 s3, 0
    s_cbranch_scc1 L_cons
    s_setprio 3
    v_mov_b32 v4, 0x80000000
    ds_write_b32 v10, v4
    v_lshl_add_u32 v14, v1, 2, 4
    v_mov_b32 v13, -64
    ds_write_b32 v14, v13
    v_lshlrev_b32 v16, 4, v1
    v_lshrrev_b32 v4, 3, v1
    v_and_b32 v5, 6, v4
    v_and_b32 v6, 7, v1
    v_xor_b32 v5, v5, v6
    v_lshlrev_b32 v5, 4, v5
    v_lshl_add_u32 v20, v4, 13, v5
    v_add_u32 v21, 0xfc00, v20
    v_add_u32 v22, 0x1f800, v20
    v_add_u32 v23, 0x2f400, v20
    v_mul_u32_u24 v6, 7168, v4
    v_add_u32 v24, v6, v5
    v_add_u32 v25, 0xdc00, v24
    v_add_u32 v26, 0x1b800, v24
    v_add_u32 v27, 0x29400, v24
    s_lshl_b32 s6, s49, 21
    s_lshl_b32 s7, s61, 7
    s_add_u32 s64, s6, s7
    s_mul_i32 s6, s49, 0x1c0000
    s_lshl_b32 s7, s62, 7
    s_add_u32 s65, s6, s7
    s_mov_b32 m0, 114688
    s_waitcnt lgkmcnt(0)
    s_load_dword s34, s[32:33], 0
    s_mov_b64 s[40:41], s[8:9]
    s_barrier
    v_mov_b32 v13, -40
    s_movk_i32 s38, 4
L_tile_1:
    s_waitcnt vmcnt(40)
    ds_write_b32 v14, v13
    global_load_lds_dwordx4 v16, s[40:41] offset:0
    s_waitcnt vmcnt(40)
    global_load_lds_dwordx4 v16, s[40:41] offset:1024
    s_waitcnt vmcnt(40)
    global_load_lds_dwordx4 v16, s[40:41] offset:2048
    s_waitcnt vmcnt(40)
    global_load_lds_dwordx4 v16, s[40:41] offset:3072
    v_add_u32 v13, 4, v13
    s_add_u32 m0, m0, 4096
    s_add_u32 s40, s40, 0x1000
    s_addc_u32 s41, s41, 0
    s_sub_u32 s38, s38, 1
    s_cmp_lg_u32 s38, 0
    s_cbranch_scc1 L_tile_1
    s_mov_b32 m0, 16384
    s_add_u32 s40, s14, s64
    s_addc_u32 s41, s15, 0
    s_movk_i32 s38, 4
L_tile_2:
    s_waitcnt vmcnt(40)
    ds_write_b32 v14, v13
    global_load_lds_dwordx4 v20, s[40:41] offset:0 nt
    s_waitcnt vmcnt(40)
    global_load_lds_dwordx4 v21, s[40:41] offset:1024 nt
    s_waitcnt vmcnt(40)
    global_load_lds_dwordx4 v22, s[40:41] offset:2048 nt
    s_waitcnt vmcnt(40)
    global_load_lds_dwordx4 v23, s[40:41] offset:3072 nt
    v_add_u32 v13, 4, v13
    s_add_u32 m0, m0, 4096
    s_add_u32 s40, s40, 0x40000
    s_addc_u32 s41, s41, 0
    s_sub_u32 s38, s38, 1
    s_cmp_lg_u32 s38, 0
    s_cbranch_scc1 L_tile_2
    v_lshrrev_b32 v4, 4, v1
    v_and_b32 v5, 15, v1
    v_xor_b32 v6, v5, v4
    v_lshlrev_b32 v6, 4, v6
    v_lshl_add_u32 v28, v4, 8, v6
    v_xor_b32 v29, 0x40, v28
    v_xor_b32 v30, 0x80, v28
    v_xor_b32 v31, 0xc0, v28
    v_lshlrev_b32 v6, 1, v4
    v_xor_b32 v6, v5, v6
    v_lshlrev_b32 v6, 4, v6
    v_lshl_add_u32 v32, v4, 8, v6
    v_xor_b32 v33, 0x80, v32
    v_mov_b32 v34, v32
    v_mov_b32 v35, v33
    v_lshl_add_u32 v36, v4, 11, v6
    v_xor_b32 v7, 0x80, v36
    v_add_u32 v37, 0x1c00, v7
    v_add_u32 v38, 0x3800, v36
    v_add_u32 v39, 0x5400, v7
    v_and_b32 v5, 1, v4
    v_lshrrev_b32 v6, 1, v4
    v_lshl_add_u32 v5, v5, 1, v6
    v_and_b32 v6, 4, v1
    v_add_u32 v5, v6, v5
    v_bfe_u32 v6, v1, 2, 1
    v_lshl_add_u32 v5, v4, 1, v6
    s_lshr_b32 s6, s2, 1
    s_lshl_b32 s6, s6, 4
    v_lshl_add_u32 v40, v5, 1, s6
    s_and_b32 s6, s2, 1
    s_lshl_b32 s6, s6, 13
    v_and_b32 v6, 3, v1
    v_lshlrev_b32 v6, 11, v6
    v_add3_u32 v41, s6, v40, v6
    global_load_ushort v42, v40, s[26:27]
    global_load_ushort v43, v41, s[8:9]
    s_movk_i32 s38, 4
L_tile_3:
    s_waitcnt vmcnt(40)
    ds_write_b32 v14, v13
    global_load_lds_dwordx4 v20, s[40:41] offset:0 nt
    s_waitcnt vmcnt(40)
    global_load_lds_dwordx4 v21, s[40:41] offset:1024 nt
    s_waitcnt vmcnt(40)
    global_load_lds_dwordx4 v22, s[40:41] offset:2048 nt
    s_waitcnt vmcnt(40)
    global_load_lds_dwordx4 v23, s[40:41] offset:3072 nt
    v_add_u32 v13, 4, v13
    s_add_u32 m0, m0, 4096
    s_add_u32 s40, s40, 0x40000
    s_addc_u32 s41, s41, 0
    s_sub_u32 s38, s38, 1
    s_cmp_lg_u32 s38, 0
    s_cbranch_scc1 L_tile_3
    s_waitcnt vmcnt(40)
    ds_write_b32 v14, v13
    v_add_u32 v13, 4, v13
    s_waitcnt vmcnt(36)
    ds_write_b32 v14, v13
    v_add_u32 v13, 4, v13
    s_waitcnt vmcnt(32)
    ds_write_b32 v14, v13
    v_add_u32 v13, 4, v13
    s_waitcnt vmcnt(28)
    ds_write_b32 v14, v13
    v_add_u32 v13, 4, v13
    s_waitcnt vmcnt(24)
    ds_write_b32 v14, v13
    v_add_u32 v13, 4, v13
    s_cmp_ge_u32 s5, 28
    s_cbranch_scc1 L_now1
    s_add_u32 s40, s20, s65
    s_addc_u32 s41, s21, 0
    s_movk_i32 s38, 8
L_tile_4:
    s_waitcnt vmcnt(20)
    ds_write_b32 v14, v13
    global_load_lds_dwordx4 v24, s[40:41] offset:0 nt
    s_waitcnt vmcnt(20)
    global_load_lds_dwordx4 v25, s[40:41] offset:1024 nt
    s_waitcnt vmcnt(20)
    global_load_lds_dwordx4 v26, s[40:41] offset:2048 nt
    s_waitcnt vmcnt(20)
    global_load_lds_dwordx4 v27, s[40:41] offset:3072 nt
    v_add_u32 v13, 4, v13
    s_add_u32 m0, m0, 4096
    s_add_u32 s40, s40, 0x38000
    s_addc_u32 s41, s41, 0
    s_sub_u32 s38, s38, 1
    s_cmp_lg_u32 s38, 0
    s_cbranch_scc1 L_tile_4
L_now1:
    s_lshl_b32 s6, s47, 20
    s_lshl_b32 s7, s48, 15
    s_add_u32 s66, s6, s7
    s_add_u32 s66, s66, 0xc0000
    s_lshl_b32 s67, s59, 12
    s_movk_i32 s38, 8
L_tile_5:
    s_add_u32 m0, s67, 81920
    s_add_u32 s7, s66, s67
    s_add_u32 s40, s10, s7
    s_addc_u32 s41, s11, 0
    s_waitcnt vmcnt(20)
    ds_write_b32 v14, v13
    global_load_lds_dwordx4 v28, s[40:41] offset:0 nt
    s_waitcnt vmcnt(20)
    global_load_lds_dwordx4 v29, s[40:41] offset:1024 nt
    s_waitcnt vmcnt(20)
    global_load_lds_dwordx4 v30, s[40:41] offset:2048 nt
    s_waitcnt vmcnt(20)
    global_load_lds_dwordx4 v31, s[40:41] offset:3072 nt
    v_add_u32 v13, 4, v13
    s_add_u32 s67, s67, 4096
    s_and_b32 s67, s67, 0x7fff
    s_sub_u32 s38, s38, 1
    s_cmp_lg_u32 s38, 0
    s_cbranch_scc1 L_tile_5
L_w_6:
    ds_read_b64 v[2:3], v10
    s_waitcnt lgkmcnt(0)
    v_readfirstlane_b32 s6, v2
    s_bitcmp1_b32 s6, 3
    s_cbranch_scc1 L_wd_7
    s_sub_i32 s37, s37, 1
    s_cmp_gt_i32 s37, 0
    s_cbranch_scc1 L_w_6
L_wd_7:
    s_movk_i32 s38, 8
L_tile_8:
    s_add_u32 m0, s67, 114688
    s_add_u32 s7, s66, s67
    s_add_u32 s40, s12, s7
    s_addc_u32 s41, s13, 0
    s_waitcnt vmcnt(20)
    ds_write_b32 v14, v13
    global_load_lds_dwordx4 v32, s[40:41] offset:0 nt
    s_waitcnt vmcnt(20)
    global_load_lds_dwordx4 v33, s[40:41] offset:1024 nt
    s_waitcnt vmcnt(20)
    global_load_lds_dwordx4 v34, s[40:41] offset:2048 nt
    s_waitcnt vmcnt(20)
    global_load_lds_dwordx4 v35, s[40:41] offset:3072 nt
    v_add_u32 v13, 4, v13
    s_add_u32 s67, s67, 4096
    s_and_b32 s67, s67, 0x7fff
    s_sub_u32 s38, s38, 1
    s_cmp_lg_u32 s38, 0
    s_cbranch_scc1 L_tile_8
L_w_9:
    ds_read_b64 v[2:3], v10
    s_waitcnt lgkmcnt(0)
    v_readfirstlane_b32 s6, v2
    s_bitcmp1_b32 s6, 7
    s_cbranch_scc1 L_wd_10
    s_sub_i32 s37, s37, 1
    s_cmp_gt_i32 s37, 0
    s_cbranch_scc1 L_w_9
L_wd_10:
    s_mul_i32 s6, s47, 229376
    s_lshl_b32 s7, s48, 8
    s_add_u32 s6, s6, s7
    s_mov_b32 m0, 16384
    s_add_u32 s40, s24, s6
    s_addc_u32 s41, s25, 0
    s_movk_i32 s38, 7
L_tile_11:
    s_waitcnt vmcnt(20)
    ds_write_b32 v14, v13
    global_load_lds_dwordx4 v36, s[40:41] offset:0 nt
    s_waitcnt vmcnt(20)
    global_load_lds_dwordx4 v37, s[40:41] offset:1024 nt
    s_waitcnt vmcnt(20)
    global_load_lds_dwordx4 v38, s[40:41] offset:2048 nt
    s_waitcnt vmcnt(20)
    global_load_lds_dwordx4 v39, s[40:41] offset:3072 nt
    v_add_u32 v13, 4, v13
    s_add_u32 m0, m0, 4096
    s_add_u32 s40, s40, 0x8000
    s_addc_u32 s41, s41, 0
    s_sub_u32 s38, s38, 1
    s_cmp_lg_u32 s38, 0
    s_cbranch_scc1 L_tile_11
    s_lshl_b32 s6, s47, 18
    s_add_u32 s6, s6, s7
    s_mov_b32 m0, 49152
    s_add_u32 s40, s16, s6
    s_addc_u32 s41, s17, 0
    s_movk_i32 s38, 8
L_tile_12:
    s_waitcnt vmcnt(20)
    ds_write_b32 v14, v13
    global_load_lds_dwordx4 v36, s[40:41] offset:0 nt
    s_waitcnt vmcnt(20)
    global_load_lds_dwordx4 v37, s[40:41] offset:1024 nt
    s_waitcnt vmcnt(20)
    global_load_lds_dwordx4 v38, s[40:41] offset:2048 nt
    s_waitcnt vmcnt(20)
    global_load_lds_dwordx4 v39, s[40:41] offset:3072 nt
    v_add_u32 v13, 4, v13
    s_add_u32 m0, m0, 4096
    s_add_u32 s40, s40, 0x8000
    s_addc_u32 s41, s41, 0
    s_sub_u32 s38, s38, 1
    s_cmp_lg_u32 s38, 0
    s_cbranch_scc1 L_tile_12
    s_waitcnt vmcnt(20)
    ds_write_b32 v14, v13
    v_add_u32 v13, 4, v13
    s_add_u32 s35, s34, 1
    s_mul_i32 s36, s35, 0x9e3779b1
    v_mov_b32 v11, s36
    s_mov_b32 s54, 0x0c0c0400
    s_mov_b32 s55, 0x04000c0c
    v_lshrrev_b32 v5, 3, v1
    v_and_b32 v6, 7, v1
    v_lshlrev_b32 v6, 4, v6
    v_lshl_add_u32 v44, v5, 15, v6
    v_add_u32 v45, 0x40000, v44
    v_add_u32 v46, 0x80000, v44
    v_add_u32 v47, 0xc0000, v44
    s_lshl_b32 s6, s4, 12
    s_lshl_b32 s7, s5, 7
    s_add_u32 s6, s6, s7
    s_add_u32 s7, s6, 0x500000
    s_add_u32 s68, s32, s7
    s_addc_u32 s69, s33, 0
    s_add_u32 s7, s6, 0x700000
    s_add_u32 s70, s32, s7
    s_addc_u32 s71, s33, 0
    s_bfe_u32 s92, s36, 0xa0000
    s_bfe_u32 s93, s36, 0xa000a
    s_bfe_u32 s94, s36, 0xa0014
    s_lshl_b32 s6, s2, 6
    s_add_u32 s7, s6, 0x700000
    s_add_u32 s70, s32, s7
    s_addc_u32 s71, s33, 0
    s_add_u32 s7, s6, 0x500000
    s_add_u32 s68, s32, s7
    s_addc_u32 s69, s33, 0
    v_lshrrev_b32 v5, 2, v1
    v_and_b32 v6, 3, v1
    v_lshlrev_b32 v6, 4, v6
    v_lshl_add_u32 v50, v5, 14, v6
    v_add_u32 v51, 0x40000, v50
    s_mov_b32 s80, 0xf0f0f0f0
    s_mov_b32 s81, 0xf0f0f0f0
    v_lshlrev_b32 v42, 16, v42
    v_lshlrev_b32 v43, 16, v43
    s_waitcnt vmcnt(16)
    ds_write_b32 v14, v13
    v_add_u32 v13, 4, v13
    s_waitcnt vmcnt(12)
    ds_write_b32 v14, v13
    v_add_u32 v13, 4, v13
    s_waitcnt vmcnt(8)
    ds_write_b32 v14, v13
    v_add_u32 v13, 4, v13
    s_waitcnt vmcnt(4)
    ds_write_b32 v14, v13
    v_add_u32 v13, 4, v13
    s_waitcnt vmcnt(0)
    ds_write_b32 v14, v13
L_w_13:
    ds_read_b64 v[2:3], v10
    s_waitcnt lgkmcnt(0)
    v_readfirstlane_b32 s6, v2
    s_bitcmp1_b32 s6, 23
    s_cbranch_scc1 L_wd_14
    s_sub_i32 s37, s37, 1
    s_cmp_gt_i32 s37, 0
    s_cbranch_scc1 L_w_13
L_wd_14:
    global_load_dwordx4 v[80:83], v50, s[70:71] offset:0 sc1
    global_load_dwordx4 v[84:87], v51, s[70:71] offset:0 sc1
    global_load_dwordx4 v[64:67], v50, s[68:69] offset:0 sc1
    global_load_dwordx4 v[68:71], v51, s[68:69] offset:0 sc1
    s_waitcnt vmcnt(2)
    v_xor_b32 v5, s92, v81
    v_xor_b32 v6, s93, v82
    v_xor_b32 v7, s94, v83
    v_or3_b32 v6, v5, v6, v7
    v_and_b32 v6, 0x3ff, v6
    v_cmp_ne_u32 s[84:85], 0, v6
    v_xor_b32 v5, s92, v85
    v_xor_b32 v6, s93, v86
    v_xor_b32 v7, s94, v87
    v_or3_b32 v6, v5, v6, v7
    v_and_b32 v6, 0x3ff, v6
    v_cmp_ne_u32 s[86:87], 0, v6
    s_or_b64 vcc, s[84:85], s[86:87]
    s_cbranch_scc1 L_retry_15
L_join_16:
    v_lshlrev_b32 v112, 21, v80
    v_bfe_i32 v96, v80, 10, 11
    v_ashrrev_i32 v97, 21, v80
    v_bfe_i32 v98, v81, 10, 11
    v_ashrrev_i32 v99, 21, v81
    v_bfe_i32 v100, v82, 10, 11
    v_ashrrev_i32 v101, 21, v82
    v_bfe_i32 v102, v83, 10, 11
    v_ashrrev_i32 v103, 21, v83
    v_and_b32 v112, 0x7f800000, v112
    v_subrev_u32 v112, 0x4800000, v112
    v_cvt_f32_i32 v96, v96
    v_cvt_f32_i32 v97, v97
    v_cvt_f32_i32 v98, v98
    v_cvt_f32_i32 v99, v99
    v_cvt_f32_i32 v100, v100
    v_cvt_f32_i32 v101, v101
    v_cvt_f32_i32 v102, v102
    v_cvt_f32_i32 v103, v103
    v_lshlrev_b32 v113, 21, v84
    v_bfe_i32 v104, v84, 10, 11
    v_ashrrev_i32 v105, 21, v84
    v_bfe_i32 v106, v85, 10, 11
    v_ashrrev_i32 v107, 21, v85
    v_bfe_i32 v108, v86, 10, 11
    v_ashrrev_i32 v109, 21, v86
    v_bfe_i32 v110, v87, 10, 11
    v_ashrrev_i32 v111, 21, v87
    v_and_b32 v113, 0x7f800000, v113
    v_subrev_u32 v113, 0x4800000, v113
    v_cvt_f32_i32 v104, v104
    v_cvt_f32_i32 v105, v105
    v_cvt_f32_i32 v106, v106
    v_cvt_f32_i32 v107, v107
    v_cvt_f32_i32 v108, v108
    v_cvt_f32_i32 v109, v109
    v_cvt_f32_i32 v110, v110
    v_cvt_f32_i32 v111, v111
    v_pk_mul_f32 v[96:97], v[96:97], v[112:113] op_sel_hi:[1,0]
    v_pk_mul_f32 v[98:99], v[98:99], v[112:113] op_sel_hi:[1,0]
    v_pk_mul_f32 v[100:101], v[100:101], v[112:113] op_sel_hi:[1,0]
    v_pk_mul_f32 v[102:103], v[102:103], v[112:113] op_sel_hi:[1,0]
    v_pk_fma_f32 v[96:97], v[104:105], v[112:113], v[96:97] op_sel:[0,1,0] op_sel_hi:[1,1,1]
    v_pk_fma_f32 v[98:99], v[106:107], v[112:113], v[98:99] op_sel:[0,1,0] op_sel_hi:[1,1,1]
    v_pk_fma_f32 v[100:101], v[108:109], v[112:113], v[100:101] op_sel:[0,1,0] op_sel_hi:[1,1,1]
    v_pk_fma_f32 v[102:103], v[110:111], v[112:113], v[102:103] op_sel:[0,1,0] op_sel_hi:[1,1,1]
    s_nop 0
    v_permlane32_swap_b32 v96, v100
    v_permlane32_swap_b32 v97, v101
    v_permlane32_swap_b32 v98, v102
    v_permlane32_swap_b32 v99, v103
    v_pk_add_f32 v[96:97], v[96:97], v[100:101]
    v_pk_add_f32 v[98:99], v[98:99], v[102:103]
    s_nop 1
    v_permlane16_swap_b32 v96, v98
    v_permlane16_swap_b32 v97, v99
    v_pk_add_f32 v[96:97], v[96:97], v[98:99]
    v_cndmask_b32 v80, v96, v97, s[80:81]
    v_cndmask_b32 v97, v97, v96, s[80:81]
    s_nop 1
    v_add_f32_dpp v80, v97, v80 row_ror:4 row_mask:0xf bank_mask:0xf
    s_nop 1
    v_add_f32_dpp v80, v80, v80 row_ror:8 row_mask:0xf bank_mask:0xf
    v_cvt_pk_bf16_f32 v80, v80, v80
    v_lshlrev_b32 v80, 16, v80
    v_add_f32 v5, v80, v42
    v_cvt_pk_bf16_f32 v5, v5, v5
    v_lshlrev_b32 v5, 16, v5
    v_mul_f32 v7, 0xbfb8aa3b, v5
    v_exp_f32 v7, v7
    s_nop 0
    v_add_f32 v7, 1.0, v7
    v_rcp_f32 v7, v7
    s_nop 0
    v_mul_f32 v5, v5, v7
    v_cvt_pk_bf16_f32 v5, v5, v5
    v_lshlrev_b32 v48, 16, v5
    s_waitcnt vmcnt(0)
    v_xor_b32 v5, s92, v65
    v_xor_b32 v6, s93, v66
    v_xor_b32 v7, s94, v67
    v_or3_b32 v6, v5, v6, v7
    v_and_b32 v6, 0x3ff, v6
    v_cmp_ne_u32 s[84:85], 0, v6
    v_xor_b32 v5, s92, v69
    v_xor_b32 v6, s93, v70
    v_xor_b32 v7, s94, v71
    v_or3_b32 v6, v5, v6, v7
    v_and_b32 v6, 0x3ff, v6
    v_cmp_ne_u32 s[86:87], 0, v6
    s_or_b64 vcc, s[84:85], s[86:87]
    s_cbranch_scc1 L_pp_17
L_ppd_18:
    v_lshlrev_b32 v112, 21, v64
    v_bfe_i32 v96, v64, 10, 11
    v_ashrrev_i32 v97, 21, v64
    v_bfe_i32 v98, v65, 10, 11
    v_ashrrev_i32 v99, 21, v65
    v_bfe_i32 v100, v66, 10, 11
    v_ashrrev_i32 v101, 21, v66
    v_bfe_i32 v102, v67, 10, 11
    v_ashrrev_i32 v103, 21, v67
    v_and_b32 v112, 0x7f800000, v112
    v_subrev_u32 v112, 0x4800000, v112
    v_cvt_f32_i32 v96, v96
    v_cvt_f32_i32 v97, v97
    v_cvt_f32_i32 v98, v98
    v_cvt_f32_i32 v99, v99
    v_cvt_f32_i32 v100, v100
    v_cvt_f32_i32 v101, v101
    v_cvt_f32_i32 v102, v102
    v_cvt_f32_i32 v103, v103
    v_lshlrev_b32 v113, 21, v68
    v_bfe_i32 v104, v68, 10, 11
    v_ashrrev_i32 v105, 21, v68
    v_bfe_i32 v106, v69, 10, 11
    v_ashrrev_i32 v107, 21, v69
    v_bfe_i32 v108, v70, 10, 11
    v_ashrrev_i32 v109, 21, v70
    v_bfe_i32 v110, v71, 10, 11
    v_ashrrev_i32 v111, 21, v71
    v_and_b32 v113, 0x7f800000, v113
    v_subrev_u32 v113, 0x4800000, v113
    v_cvt_f32_i32 v104, v104
    v_cvt_f32_i32 v105, v105
    v_cvt_f32_i32 v106, v106
    v_cvt_f32_i32 v107, v107
    v_cvt_f32_i32 v108, v108
    v_cvt_f32_i32 v109, v109
    v_cvt_f32_i32 v110, v110
    v_cvt_f32_i32 v111, v111
    v_pk_mul_f32 v[96:97], v[96:97], v[112:113] op_sel_hi:[1,0]
    v_pk_mul_f32 v[98:99], v[98:99], v[112:113] op_sel_hi:[1,0]
    v_pk_mul_f32 v[100:101], v[100:101], v[112:113] op_sel_hi:[1,0]
    v_pk_mul_f32 v[102:103], v[102:103], v[112:113] op_sel_hi:[1,0]
    v_pk_fma_f32 v[96:97], v[104:105], v[112:113], v[96:97] op_sel:[0,1,0] op_sel_hi:[1,1,1]
    v_pk_fma_f32 v[98:99], v[106:107], v[112:113], v[98:99] op_sel:[0,1,0] op_sel_hi:[1,1,1]
    v_pk_fma_f32 v[100:101], v[108:109], v[112:113], v[100:101] op_sel:[0,1,0] op_sel_hi:[1,1,1]
    v_pk_fma_f32 v[102:103], v[110:111], v[112:113], v[102:103] op_sel:[0,1,0] op_sel_hi:[1,1,1]
    s_nop 0
    v_permlane32_swap_b32 v96, v100
    v_permlane32_swap_b32 v97, v101
    v_permlane32_swap_b32 v98, v102
    v_permlane32_swap_b32 v99, v103
    v_pk_add_f32 v[96:97], v[96:97], v[100:101]
    v_pk_add_f32 v[98:99], v[98:99], v[102:103]
    s_nop 1
    v_permlane16_swap_b32 v96, v98
    v_permlane16_swap_b32 v97, v99
    v_pk_add_f32 v[96:97], v[96:97], v[98:99]
    v_cndmask_b32 v64, v96, v97, s[80:81]
    v_cndmask_b32 v97, v97, v96, s[80:81]
    s_nop 1
    v_add_f32_dpp v64, v97, v64 row_ror:4 row_mask:0xf bank_mask:0xf
    s_nop 1
    v_add_f32_dpp v64, v64, v64 row_ror:8 row_mask:0xf bank_mask:0xf
    v_cvt_pk_bf16_f32 v64, v64, v64
    v_lshlrev_b32 v64, 16, v64
    v_mul_f32 v5, v48, v64
    v_cvt_pk_bf16_f32 v5, v5, v5
    v_lshlrev_b32 v5, 16, v5
    v_add_f32 v5, v5, v43
    v_cvt_pk_bf16_f32 v5, v5, v5
    s_mov_b32 exec_lo, 0x00ff00ff
    s_mov_b32 exec_hi, 0x00ff00ff
    global_store_short v41, v5, s[28:29]
    s_cmp_lg_u32 s2, 0
    s_cbranch_scc1 L_end
    s_mov_b64 exec, 1
    v_mov_b32 v4, s35
    global_store_dword v10, v4, s[32:33] sc1
    s_endpgm
L_pp_17:
    s_mov_b64 s[88:89], s[84:85]
    s_mov_b64 s[90:91], s[86:87]
    v_mov_b32 v116, v64
    v_mov_b32 v117, v65
    v_mov_b32 v118, v66
    v_mov_b32 v119, v67
    v_mov_b32 v120, v68
    v_mov_b32 v121, v69
    v_mov_b32 v122, v70
    v_mov_b32 v123, v71
    v_mov_b32 v124, v64
    v_mov_b32 v125, v65
    v_mov_b32 v126, v66
    v_mov_b32 v127, v67
    v_mov_b32 v128, v68
    v_mov_b32 v129, v69
    v_mov_b32 v130, v70
    v_mov_b32 v131, v71
    s_or_b64 exec, s[88:89], 1
    global_load_dwordx4 v[116:119], v50, s[68:69] offset:0 sc1
    s_or_b64 exec, s[90:91], 1
    global_load_dwordx4 v[120:123], v51, s[68:69] offset:0 sc1
    s_mov_b64 exec, -1
    s_movk_i32 s6, 3
L_dl_19:
    s_nop 15
    s_nop 15
    s_sub_u32 s6, s6, 1
    s_cmp_lg_u32 s6, 0
    s_cbranch_scc1 L_dl_19
    s_or_b64 exec, s[88:89], 1
    global_load_dwordx4 v[124:127], v50, s[68:69] offset:0 sc1
    s_or_b64 exec, s[90:91], 1
    global_load_dwordx4 v[128:131], v51, s[68:69] offset:0 sc1
    s_mov_b64 exec, -1
    s_movk_i32 s38, 20000
L_ppl_20:
    s_waitcnt vmcnt(2)
    v_xor_b32 v5, s92, v117
    v_xor_b32 v6, s93, v118
    v_xor_b32 v7, s94, v119
    v_or3_b32 v6, v5, v6, v7
    v_and_b32 v6, 0x3ff, v6
    v_cmp_ne_u32 s[84:85], 0, v6
    v_xor_b32 v5, s92, v121
    v_xor_b32 v6, s93, v122
    v_xor_b32 v7, s94, v123
    v_or3_b32 v6, v5, v6, v7
    v_and_b32 v6, 0x3ff, v6
    v_cmp_ne_u32 s[86:87], 0, v6
    s_or_b64 vcc, s[84:85], s[86:87]
    s_andn2_b64 exec, s[88:89], s[84:85]
    v_mov_b32 v64, v116
    v_mov_b32 v65, v117
    v_mov_b32 v66, v118
    v_mov_b32 v67, v119
    s_and_b64 s[88:89], s[88:89], s[84:85]
    s_andn2_b64 exec, s[90:91], s[86:87]
    v_mov_b32 v68, v120
    v_mov_b32 v69, v121
    v_mov_b32 v70, v122
    v_mov_b32 v71, v123
    s_and_b64 s[90:91], s[90:91], s[86:87]
    s_mov_b64 exec, -1
    s_or_b64 vcc, s[88:89], s[90:91]
    s_cbranch_scc0 L_ppd_18
    s_or_b64 exec, s[88:89], 1
    global_load_dwordx4 v[116:119], v50, s[68:69] offset:0 sc1
    s_or_b64 exec, s[90:91], 1
    global_load_dwordx4 v[120:123], v51, s[68:69] offset:0 sc1
    s_mov_b64 exec, -1
    s_waitcnt vmcnt(2)
    v_xor_b32 v5, s92, v125
    v_xor_b32 v6, s93, v126
    v_xor_b32 v7, s94, v127
    v_or3_b32 v6, v5, v6, v7
    v_and_b32 v6, 0x3ff, v6
    v_cmp_ne_u32 s[84:85], 0, v6
    v_xor_b32 v5, s92, v129
    v_xor_b32 v6, s93, v130
    v_xor_b32 v7, s94, v131
    v_or3_b32 v6, v5, v6, v7
    v_and_b32 v6, 0x3ff, v6
    v_cmp_ne_u32 s[86:87], 0, v6
    s_or_b64 vcc, s[84:85], s[86:87]
    s_andn2_b64 exec, s[88:89], s[84:85]
    v_mov_b32 v64, v124
    v_mov_b32 v65, v125
    v_mov_b32 v66, v126
    v_mov_b32 v67, v127
    s_and_b64 s[88:89], s[88:89], s[84:85]
    s_andn2_b64 exec, s[90:91], s[86:87]
    v_mov_b32 v68, v128
    v_mov_b32 v69, v129
    v_mov_b32 v70, v130
    v_mov_b32 v71, v131
    s_and_b64 s[90:91], s[90:91], s[86:87]
    s_mov_b64 exec, -1
    s_or_b64 vcc, s[88:89], s[90:91]
    s_cbranch_scc0 L_ppd_18
    s_or_b64 exec, s[88:89], 1
    global_load_dwordx4 v[124:127], v50, s[68:69] offset:0 sc1
    s_or_b64 exec, s[90:91], 1
    global_load_dwordx4 v[128:131], v51, s[68:69] offset:0 sc1
    s_mov_b64 exec, -1
    s_sub_u32 s38, s38, 1
    s_cmp_lg_u32 s38, 0
    s_cbranch_scc1 L_ppl_20
    s_branch L_ppd_18
L_retry_15:
    s_movk_i32 s38, 20000
L_loop_21:
    s_cmp_eq_u64 s[84:85], 0
    s_cbranch_scc1 L_sk_22
    global_load_dwordx4 v[80:83], v50, s[70:71] offset:0 sc1
L_sk_22:
    s_cmp_eq_u64 s[86:87], 0
    s_cbranch_scc1 L_sk_23
    global_load_dwordx4 v[84:87], v51, s[70:71] offset:0 sc1
L_sk_23:
    s_waitcnt vmcnt(0)
    v_xor_b32 v5, s92, v81
    v_xor_b32 v6, s93, v82
    v_xor_b32 v7, s94, v83
    v_or3_b32 v6, v5, v6, v7
    v_and_b32 v6, 0x3ff, v6
    v_cmp_ne_u32 s[84:85], 0, v6
    v_xor_b32 v5, s92, v85
    v_xor_b32 v6, s93, v86
    v_xor_b32 v7, s94, v87
    v_or3_b32 v6, v5, v6, v7
    v_and_b32 v6, 0x3ff, v6
    v_cmp_ne_u32 s[86:87], 0, v6
    s_or_b64 vcc, s[84:85], s[86:87]
    s_cbranch_scc0 L_join_16
    s_sub_u32 s38, s38, 1
    s_cmp_lg_u32 s38, 0
    s_cbranch_scc1 L_loop_21
    s_branch L_join_16
L_cons:
    s_barrier
    s_sub_u32 s46, s3, 1
    v_lshrrev_b32 v4, 4, v1
    v_and_b32 v5, 15, v1
    v_and_b32 v6, 7, v1
    v_and_b32 v7, 31, v1
    v_lshlrev_b32 v28, 4, v1
    v_lshlrev_b32 v29, 3, v1
    v_lshlrev_b32 v164, 9, v6
    v_min_u32 v9, 27, v7
    v_lshlrev_b32 v2, 3, v9
    s_mul_i32 s6, s47, 224
    s_waitcnt lgkmcnt(0)
    s_load_dword s34, s[32:33], 0
    s_min_u32 s7, s46, 6
    s_lshl_b32 s7, s7, 5
    s_add_u32 s6, s6, s7
    v_and_b32 v2, 8, v1
    v_lshlrev_b32 v2, 1, v2
    v_lshl_add_u32 v2, v4, 2, v2
    s_add_u32 s42, s22, s6
    s_addc_u32 s43, s23, 0
    global_load_dword v8, v2, s[42:43]
    v_mul_u32_u24 v3, 272, v6
    v_add3_u32 v165, v3, v2, s7
    v_lshrrev_b32 v2, 5, v1
    v_lshlrev_b32 v2, 7, v2
    v_lshl_add_u32 v166, v6, 4, v2
    v_lshrrev_b32 v2, 5, v1
    v_lshlrev_b32 v2, 17, v2
    v_lshl_add_u32 v26, v7, 4, v2
    v_min_u32 v3, 27, v7
    v_lshl_add_u32 v27, v3, 4, v2
    s_mul_i32 s6, s46, 272
    v_lshl_add_u32 v30, v7, 3, s6
    v_lshlrev_b32 v2, 4, v4
    v_lshl_add_u32 v24, v5, 14, v2
    v_lshl_add_u32 v27, v5, 6, v2
    v_lshl_add_u32 v25, v5, 12, v2
    v_mul_u32_u24 v3, 272, v6
    v_add3_u32 v16, v3, v2, 0x40
    v_add_u32 v16, 960, v16
    v_lshl_add_u32 v3, v4, 3, v3
    v_add_u32 v14, 3200, v3
    v_add_u32 v15, 5376, v3
    v_mul_u32_u24 v3, 528, v6
    v_lshl_add_u32 v3, v4, 3, v3
    v_add_u32 v13, 7552, v3
    v_mul_u32_u24 v3, 80, v6
    v_add_u32 v31, 320, v3
    v_xor_b32 v3, v4, v5
    v_lshlrev_b32 v3, 4, v3
    v_lshl_add_u32 v3, v5, 8, v3
    s_lshl_b32 s6, s46, 12
    s_add_u32 s6, s6, 81920
    v_add_u32 v18, s6, v3
    v_xor_b32 v19, 0x40, v18
    v_xor_b32 v20, 0x80, v18
    v_xor_b32 v21, 0xc0, v18
    v_lshrrev_b32 v2, 2, v1
    v_bfe_u32 v3, v1, 1, 1
    v_and_b32 v4, 1, v1
    v_lshlrev_b32 v4, 3, v4
    s_lshl_b32 s6, s46, 1
    v_or_b32 v5, s6, v3
    v_and_b32 v6, 7, v2
    v_lshlrev_b32 v6, 1, v6
    v_xor_b32 v5, v5, v6
    v_lshl_add_u32 v5, v5, 4, v4
    v_lshl_add_u32 v5, v2, 8, v5
    v_add_u32 v22, 0x1c000, v5
    v_add_u32 v23, 0x4000, v5
    s_and_b32 s6, s6, 6
    v_or_b32 v5, s6, v3
    v_and_b32 v6, 6, v2
    v_xor_b32 v5, v5, v6
    v_lshl_add_u32 v5, v5, 4, v4
    v_lshl_add_u32 v5, v2, 7, v5
    s_lshr_b32 s7, s46, 2
    s_lshl_b32 s6, s7, 15
    s_add_u32 s6, s6, 16384
    v_add_u32 v17, s6, v5
    s_cmp_eq_u32 s7, 0
    s_cselect_b32 s6, s61, s62
    s_cselect_b32 s63, 48, 80
    s_lshl_b32 s6, s6, 8
    s_add_u32 s7, s7, 1
    s_lshl_b32 s7, s7, 20
    s_add_u32 s6, s6, s7
    s_lshl_b32 s7, s49, 17
    s_add_u32 s6, s6, s7
    s_and_b32 s7, s46, 3
    s_lshl_b32 s7, s7, 6
    s_add_u32 s6, s6, s7
    s_lshl_b32 s7, s62, 2
    s_add_u32 s7, s7, s46
    s_lshl_b32 s7, s7, 2
    s_add_u32 s7, s7, s49
    s_lshl_b32 s7, s7, 8
    s_add_u32 s7, s7, 0x1ff000
    s_cmp_lt_u32 s46, 4
    s_cselect_b32 s6, s6, s7
    s_add_u32 s64, s32, s6
    s_addc_u32 s65, s33, 0
    s_lshl_b32 s6, s47, 3
    s_add_u32 s6, s6, s46
    s_lshl_b32 s6, s6, 9
    s_add_u32 s6, s6, 0x100000
    s_add_u32 s66, s32, s6
    s_addc_u32 s67, s33, 0
    s_add_u32 s68, s66, 0x40000
    s_addc_u32 s69, s67, 0
    s_lshl_b32 s6, s46, 14
    s_mul_i32 s7, s47, 448
    s_add_u32 s6, s6, s7
    s_add_u32 s6, s6, 0x200000
    s_add_u32 s70, s32, s6
    s_addc_u32 s71, s33, 0
    s_add_u32 s72, s70, 0x40000
    s_addc_u32 s73, s71, 0
    s_mul_i32 s6, s47, 7
    s_min_u32 s7, s46, 6
    s_add_u32 s6, s6, s7
    s_lshl_b32 s6, s6, 10
    s_add_u32 s6, s6, 0x200000
    s_add_u32 s70, s32, s6
    s_addc_u32 s71, s33, 0
    s_lshl_b32 s6, s47, 15
    s_lshl_b32 s7, s48, 9
    s_add_u32 s6, s6, s7
    s_lshl_b32 s7, s46, 6
    s_add_u32 s6, s6, s7
    s_add_u32 s6, s6, 0x300000
    s_add_u32 s74, s32, s6
    s_addc_u32 s75, s33, 0
    s_add_u32 s76, s74, 0x200000
    s_addc_u32 s77, s75, 0
    s_add_u32 s78, s74, 0x400000
    s_addc_u32 s79, s75, 0
    s_lshl_b32 s6, s47, 3
    s_add_u32 s6, s6, s48
    s_lshl_b32 s6, s6, 3
    s_add_u32 s6, s6, s46
    s_lshl_b32 s6, s6, 8
    s_add_u32 s7, s6, 0x700000
    s_add_u32 s78, s32, s7
    s_addc_u32 s79, s33, 0
    s_add_u32 s7, s6, 0x500000
    s_add_u32 s76, s32, s7
    s_addc_u32 s77, s33, 0
    v_lshrrev_b32 v2, 5, v1
    v_bfe_u32 v3, v1, 2, 1
    v_lshl_add_u32 v2, v2, 1, v3
    v_bfe_u32 v3, v1, 4, 1
    v_lshl_add_u32 v2, v2, 1, v3
    v_and_b32 v3, 3, v1
    v_lshl_add_u32 v2, v2, 2, v3
    v_lshlrev_b32 v25, 4, v2
    s_lshl_b32 s6, s47, 3
    s_add_u32 s6, s6, s46
    s_lshl_b32 s6, s6, 3
    s_add_u32 s6, s6, s48
    s_lshl_b32 s6, s6, 8
    s_add_u32 s6, s6, 0x300000
    s_add_u32 s74, s32, s6
    s_addc_u32 s75, s33, 0
    s_lshl_b32 s6, s46, 5
    s_add_u32 s6, s6, s47
    s_lshl_b32 s6, s6, 11
    s_add_u32 s6, s6, 0x300000
    s_add_u32 s80, s32, s6
    s_addc_u32 s81, s33, 0
    s_mov_b32 s50, 0x07060500
    s_mov_b32 s51, 0x07060501
    s_mov_b32 s52, 0x07060502
    s_mov_b32 s53, 0x07060503
    s_mov_b32 s56, 0x00ff00ff
    s_mov_b32 s57, 0x00ff00ff
    s_lshl_b32 s6, s46, 11
    s_add_u32 s6, s6, 114688
    v_add_u32 v126, s6, v28
    s_lshl_b32 s7, s49, 9
    s_add_u32 s6, s6, s7
    v_add_u32 v127, s6, v29
    s_waitcnt lgkmcnt(0)
    s_add_u32 s35, s34, 1
    s_mul_i32 s36, s35, 0x9e3779b1
    v_mov_b32 v11, s36
    s_mov_b32 s54, 0x0c0c0400
    s_mov_b32 s55, 0x04000c0c
    s_mov_b32 s96, 0x0c0c0703
    s_and_b32 s97, s36, 0xffff
    s_mov_b32 s94, 0x4b400000
    s_movk_i32 s95, 0xfff
    s_mov_b32 s92, 0x0c070100
    s_and_b32 s93, s36, 0xffffff
    s_bfe_u32 s8, s36, 0xa0000
    s_bfe_u32 s9, s36, 0xa000a
    s_bfe_u32 s10, s36, 0xa0014
    s_mov_b32 s17, 0x1ffc00
    s_cmp_lt_u32 s46, 0
    s_cselect_b32 s40, 15, 0xff
    s_cselect_b32 s41, 8, 0x80
    s_cselect_b32 s7, 4, 8
    s_mov_b32 s6, s36
    v_mov_b32 v144, s6
    s_lshr_b32 s82, s36, 0
    s_lshr_b32 s6, s6, s7
    v_mov_b32 v145, s6
    s_lshr_b32 s83, s36, 4
    s_lshr_b32 s6, s6, s7
    v_mov_b32 v146, s6
    s_lshr_b32 s100, s36, 8
    s_lshr_b32 s6, s6, s7
    v_mov_b32 v147, s6
    s_lshr_b32 s101, s36, 12
L_w_24:
    ds_read_b64 v[2:3], v10
    s_waitcnt lgkmcnt(0)
    v_readfirstlane_b32 s6, v2
    v_readfirstlane_b32 s7, v3
    s_cmp_ge_i32 s7, 16
    s_cselect_b32 s6, s6, 0
    s_bitcmp1_b32 s6, 31
    s_cbranch_scc1 L_wd_25
    s_sub_i32 s37, s37, 1
    s_cmp_gt_i32 s37, 0
    s_cbranch_scc1 L_w_24
L_wd_25:
    ds_read_b128 v[32:35], v126
    ds_read_b128 v[36:39], v126 offset:1024
    ds_read_b64 v[40:41], v127
    s_waitcnt lgkmcnt(2)
    v_lshlrev_b32 v64, 16, v32
    v_and_b32 v65, 0xffff0000, v32
    v_lshlrev_b32 v66, 16, v33
    v_and_b32 v67, 0xffff0000, v33
    v_lshlrev_b32 v68, 16, v34
    v_and_b32 v69, 0xffff0000, v34
    v_lshlrev_b32 v70, 16, v35
    v_and_b32 v71, 0xffff0000, v35
    s_waitcnt lgkmcnt(1)
    v_lshlrev_b32 v72, 16, v36
    v_and_b32 v73, 0xffff0000, v36
    v_lshlrev_b32 v74, 16, v37
    v_and_b32 v75, 0xffff0000, v37
    v_lshlrev_b32 v76, 16, v38
    v_and_b32 v77, 0xffff0000, v38
    v_lshlrev_b32 v78, 16, v39
    v_and_b32 v79, 0xffff0000, v39
    v_add_f32 v96, v64, v68
    v_add_f32 v97, v65, v69
    v_add_f32 v98, v66, v70
    v_add_f32 v99, v67, v71
    v_add_f32 v80, v72, v76
    v_add_f32 v81, v73, v77
    v_add_f32 v82, v74, v78
    v_add_f32 v83, v75, v79
    v_add_f32 v96, v96, v80
    v_add_f32 v97, v97, v81
    v_add_f32 v98, v98, v82
    v_add_f32 v99, v99, v83
    v_add_f32 v96, v96, v97
    v_add_f32 v98, v98, v99
    v_add_f32 v96, v96, v98
    s_nop 1
    v_add_f32_dpp v96, v96, v96 quad_perm:[1,0,3,2] row_mask:0xf bank_mask:0xf
    s_nop 1
    v_add_f32_dpp v96, v96, v96 quad_perm:[2,3,0,1] row_mask:0xf bank_mask:0xf
    s_nop 1
    v_add_f32_dpp v96, v96, v96 row_half_mirror row_mask:0xf bank_mask:0xf
    s_nop 1
    v_add_f32_dpp v96, v96, v96 row_mirror row_mask:0xf bank_mask:0xf
    v_mov_b32 v97, v96
    s_nop 1
    v_permlane16_swap_b32 v96, v97
    v_add_f32 v96, v96, v97
    v_mov_b32 v97, v96
    s_nop 1
    v_permlane32_swap_b32 v96, v97
    v_add_f32 v96, v96, v97
    v_mul_f32 v96, 0x3a800000, v96
    v_sub_f32 v80, v64, v96
    v_sub_f32 v81, v65, v96
    v_sub_f32 v82, v66, v96
    v_sub_f32 v83, v67, v96
    v_sub_f32 v84, v68, v96
    v_sub_f32 v85, v69, v96
    v_sub_f32 v86, v70, v96
    v_sub_f32 v87, v71, v96
    v_sub_f32 v88, v72, v96
    v_sub_f32 v89, v73, v96
    v_sub_f32 v90, v74, v96
    v_sub_f32 v91, v75, v96
    v_sub_f32 v92, v76, v96
    v_sub_f32 v93, v77, v96
    v_sub_f32 v94, v78, v96
    v_sub_f32 v95, v79, v96
    v_mul_f32 v98, v80, v80
    v_mul_f32 v99, v81, v81
    v_mul_f32 v100, v82, v82
    v_mul_f32 v101, v83, v83
    v_fmac_f32 v98, v84, v84
    v_fmac_f32 v99, v85, v85
    v_fmac_f32 v100, v86, v86
    v_fmac_f32 v101, v87, v87
    v_fmac_f32 v98, v88, v88
    v_fmac_f32 v99, v89, v89
    v_fmac_f32 v100, v90, v90
    v_fmac_f32 v101, v91, v91
    v_fmac_f32 v98, v92, v92
    v_fmac_f32 v99, v93, v93
    v_fmac_f32 v100, v94, v94
    v_fmac_f32 v101, v95, v95
    v_add_f32 v98, v98, v99
    v_add_f32 v100, v100, v101
    v_add_f32 v98, v98, v100
    s_nop 1
    v_add_f32_dpp v98, v98, v98 quad_perm:[1,0,3,2] row_mask:0xf bank_mask:0xf
    s_nop 1
    v_add_f32_dpp v98, v98, v98 quad_perm:[2,3,0,1] row_mask:0xf bank_mask:0xf
    s_nop 1
    v_add_f32_dpp v98, v98, v98 row_half_mirror row_mask:0xf bank_mask:0xf
    s_nop 1
    v_add_f32_dpp v98, v98, v98 row_mirror row_mask:0xf bank_mask:0xf
    v_mov_b32 v97, v98
    s_nop 1
    v_permlane16_swap_b32 v98, v97
    v_add_f32 v98, v98, v97
    v_mov_b32 v97, v98
    s_nop 1
    v_permlane32_swap_b32 v98, v97
    v_add_f32 v98, v98, v97
    v_mul_f32 v98, 0x3a800000, v98
    v_cvt_pk_bf16_f32 v97, v96, v98
    v_lshlrev_b32 v96, 16, v97
    v_and_b32 v98, 0xffff0000, v97
    v_add_f32 v98, 0x3727c5ac, v98
    v_cvt_pk_bf16_f32 v98, v98, v98
    v_lshlrev_b32 v98, 16, v98
    v_sqrt_f32 v98, v98
    s_waitcnt lgkmcnt(0)
    v_lshlrev_b32 v64, 16, v40
    v_and_b32 v65, 0xffff0000, v40
    v_lshlrev_b32 v66, 16, v41
    v_and_b32 v67, 0xffff0000, v41
    v_cvt_pk_bf16_f32 v98, v98, v98
    v_lshlrev_b32 v98, 16, v98
    v_rcp_f32 v99, v98
    v_sub_f32 v64, v64, v96
    v_sub_f32 v65, v65, v96
    v_sub_f32 v66, v66, v96
    v_sub_f32 v67, v67, v96
    v_cvt_pk_bf16_f32 v32, v64, v65
    v_cvt_pk_bf16_f32 v33, v66, v67
    v_lshlrev_b32 v64, 16, v32
    v_and_b32 v65, 0xffff0000, v32
    v_lshlrev_b32 v66, 16, v33
    v_and_b32 v67, 0xffff0000, v33
    v_mul_f32 v80, v64, v99
    v_mul_f32 v81, v65, v99
    v_mul_f32 v82, v66, v99
    v_mul_f32 v83, v67, v99
    v_fma_f32 v64, -v80, v98, v64
    v_fma_f32 v65, -v81, v98, v65
    v_fma_f32 v66, -v82, v98, v66
    v_fma_f32 v67, -v83, v98, v67
    v_fmac_f32 v80, v64, v99
    v_fmac_f32 v81, v65, v99
    v_fmac_f32 v82, v66, v99
    v_fmac_f32 v83, v67, v99
    v_cvt_pk_bf16_f32 v32, v80, v81
    v_cvt_pk_bf16_f32 v33, v82, v83
    s_mul_i32 s6, s46, 528
    v_add_u32 v4, s6, v29
    ds_write_b64 v4, v[32:33] offset:7552
    v_mov_b32 v12, 0x1
    s_mov_b64 exec, 1
    ds_add_u32 v10, v12
    s_mov_b64 exec, -1
    s_add_i32 s7, s39, s46
    s_cmp_lt_i32 s7, 0
    s_cselect_b32 s7, s7, -32
    s_cmp_ge_i32 s7, -28
    s_cbranch_scc1 L_nop1
L_w_26:
    ds_read_b64 v[2:3], v10
    s_waitcnt lgkmcnt(0)
    v_readfirstlane_b32 s6, v2
    s_bitcmp1_b32 s6, 3
    s_cbranch_scc1 L_wd_27
    s_sub_i32 s37, s37, 1
    s_cmp_gt_i32 s37, 0
    s_cbranch_scc1 L_w_26
L_wd_27:
    ds_read2_b64 v[64:67], v13 offset0:0 offset1:4
    ds_read2_b64 v[68:71], v13 offset0:8 offset1:12
    ds_read2_b64 v[72:75], v13 offset0:16 offset1:20
    ds_read2_b64 v[76:79], v13 offset0:24 offset1:28
    ds_read2_b64 v[80:83], v13 offset0:32 offset1:36
    ds_read2_b64 v[84:87], v13 offset0:40 offset1:44
    ds_read2_b64 v[88:91], v13 offset0:48 offset1:52
    ds_read2_b64 v[92:95], v13 offset0:56 offset1:60
L_w_28:
    ds_read_b64 v[2:3], v10
    s_waitcnt lgkmcnt(0)
    v_readfirstlane_b32 s6, v2
    v_readfirstlane_b32 s7, v3
    s_cmp_ge_i32 s7, s63
    s_cselect_b32 s6, s6, 0
    s_bitcmp1_b32 s6, 31
    s_cbranch_scc1 L_wd_29
    s_sub_i32 s37, s37, 1
    s_cmp_gt_i32 s37, 0
    s_cbranch_scc1 L_w_28
L_wd_29:
    ds_read_b64_tr_b16 v[32:33], v17 offset:0
    ds_read_b64_tr_b16 v[34:35], v17 offset:2048
    ds_read_b64_tr_b16 v[36:37], v17 offset:4096
    ds_read_b64_tr_b16 v[38:39], v17 offset:6144
    ds_read_b64_tr_b16 v[40:41], v17 offset:8192
    ds_read_b64_tr_b16 v[42:43], v17 offset:10240
    ds_read_b64_tr_b16 v[44:45], v17 offset:12288
    ds_read_b64_tr_b16 v[46:47], v17 offset:14336
    ds_read_b64_tr_b16 v[48:49], v17 offset:16384
    ds_read_b64_tr_b16 v[50:51], v17 offset:18432
    ds_read_b64_tr_b16 v[52:53], v17 offset:20480
    ds_read_b64_tr_b16 v[54:55], v17 offset:22528
    ds_read_b64_tr_b16 v[56:57], v17 offset:24576
    ds_read_b64_tr_b16 v[58:59], v17 offset:26624
    ds_read_b64_tr_b16 v[60:61], v17 offset:28672
    ds_read_b64_tr_b16 v[62:63], v17 offset:30720
    s_waitcnt lgkmcnt(14)
    v_mfma_f32_16x16x32_bf16 v[96:99], v[32:35], v[64:67], 0
    s_waitcnt lgkmcnt(12)
    v_mfma_f32_16x16x32_bf16 v[100:103], v[36:39], v[68:71], 0
    s_waitcnt lgkmcnt(10)
    v_mfma_f32_16x16x32_bf16 v[96:99], v[40:43], v[72:75], v[96:99]
    s_waitcnt lgkmcnt(8)
    v_mfma_f32_16x16x32_bf16 v[100:103], v[44:47], v[76:79], v[100:103]
    s_waitcnt lgkmcnt(6)
    v_mfma_f32_16x16x32_bf16 v[96:99], v[48:51], v[80:83], v[96:99]
    s_waitcnt lgkmcnt(4)
    v_mfma_f32_16x16x32_bf16 v[100:103], v[52:55], v[84:87], v[100:103]
    s_waitcnt lgkmcnt(2)
    v_mfma_f32_16x16x32_bf16 v[96:99], v[56:59], v[88:91], v[96:99]
    s_waitcnt lgkmcnt(0)
    v_mfma_f32_16x16x32_bf16 v[100:103], v[60:63], v[92:95], v[100:103]
    s_nop 7
    v_add_f32 v96, v96, v100
    v_add_f32 v97, v97, v101
    v_add_f32 v98, v98, v102
    v_add_f32 v99, v99, v103
    s_cmp_lt_u32 s46, 4
    s_cbranch_scc1 L_p1q_30
    v_permlane16_swap_b32 v96, v100
    v_permlane16_swap_b32 v97, v101
    v_permlane16_swap_b32 v98, v102
    v_permlane16_swap_b32 v99, v103
    v_max3_f32 v4, |v96|, |v97|, |v98|
    v_max3_f32 v5, |v99|, |v100|, |v101|
    v_max3_f32 v4, |v102|, |v103|, v4
    v_max_f32 v4, v4, v5
    v_mul_f32 v4, 0x3f802000, v4
    v_max_f32 v4, 0x08000000, v4
    v_and_b32 v5, 0x7f800000, v4
    v_sub_u32 v5, 0x83800000, v5
    v_lshrrev_b32 v6, 21, v4
    v_pk_fma_f32 v[96:97], v[96:97], v[4:5], s[94:95] op_sel:[0,1,0] op_sel_hi:[1,1,0]
    v_pk_fma_f32 v[98:99], v[98:99], v[4:5], s[94:95] op_sel:[0,1,0] op_sel_hi:[1,1,0]
    v_pk_fma_f32 v[100:101], v[100:101], v[4:5], s[94:95] op_sel:[0,1,0] op_sel_hi:[1,1,0]
    v_pk_fma_f32 v[102:103], v[102:103], v[4:5], s[94:95] op_sel:[0,1,0] op_sel_hi:[1,1,0]
    v_lshlrev_b32 v96, 10, v96
    v_lshlrev_b32 v98, 10, v98
    v_lshlrev_b32 v100, 10, v100
    v_lshlrev_b32 v102, 10, v102
    v_lshl_or_b32 v97, v97, 21, v6
    v_lshl_or_b32 v99, v99, 21, s8
    v_lshl_or_b32 v101, v101, 21, s9
    v_lshl_or_b32 v103, v103, 21, s10
    v_bfi_b32 v104, s17, v96, v97
    v_bfi_b32 v105, s17, v98, v99
    v_bfi_b32 v106, s17, v100, v101
    v_bfi_b32 v107, s17, v102, v103
    s_mov_b32 exec_lo, 0xff
    s_mov_b32 exec_hi, 0xff
    global_store_dwordx4 v166, v[104:107], s[64:65] sc1
    s_branch L_p1e_31
L_p1q_30:
    v_max3_f32 v4, |v96|, |v97|, |v98|
    v_max3_f32 v4, |v99|, v4, v4
    v_mul_f32 v4, 0x3f800004, v4
    v_max_f32 v4, 0x0b000000, v4
    v_and_b32 v5, 0x7f800000, v4
    v_sub_u32 v5, 0x89000000, v5
    v_lshrrev_b32 v6, 21, v4
    v_fma_f32 v96, v96, v5, s94
    v_fma_f32 v97, v97, v5, s94
    v_fma_f32 v98, v98, v5, s94
    v_fma_f32 v99, v99, v5, s94
    v_lshl_or_b32 v96, v96, 10, v6
    v_lshl_or_b32 v97, v97, 10, s8
    v_lshl_or_b32 v98, v98, 10, s9
    v_lshl_or_b32 v99, v99, 10, s10
    s_mov_b64 exec, s[56:57]
    global_store_dwordx4 v24, v[96:99], s[64:65] sc1
L_p1e_31:
    s_mov_b64 exec, -1
L_nop1:
    v_mov_b32 v12, 0x10
    s_mov_b64 exec, 1
    ds_add_u32 v10, v12
    s_mov_b64 exec, -1
L_w_32:
    ds_read_b64 v[2:3], v10
    s_waitcnt lgkmcnt(0)
    v_readfirstlane_b32 s6, v2
    v_readfirstlane_b32 s7, v3
    s_cmp_ge_i32 s7, 88
    s_cselect_b32 s6, s6, 0
    s_bitcmp1_b32 s6, 31
    s_cbranch_scc1 L_wd_33
    s_sub_i32 s37, s37, 1
    s_cmp_gt_i32 s37, 0
    s_cbranch_scc1 L_w_32
L_wd_33:
    global_load_dwordx4 v[128:131], v26, s[66:67] offset:0 sc1
    global_load_dwordx4 v[132:135], v26, s[68:69] offset:0 sc1
    s_waitcnt vmcnt(0)
    v_xor_b32 v5, s8, v129
    v_xor_b32 v6, s9, v130
    v_xor_b32 v7, s10, v131
    v_or3_b32 v6, v5, v6, v7
    v_and_b32 v6, 0x3ff, v6
    v_cmp_ne_u32 s[84:85], 0, v6
    v_xor_b32 v5, s8, v133
    v_xor_b32 v6, s9, v134
    v_xor_b32 v7, s10, v135
    v_or3_b32 v6, v5, v6, v7
    v_and_b32 v6, 0x3ff, v6
    v_cmp_ne_u32 s[86:87], 0, v6
    s_or_b64 vcc, s[84:85], s[86:87]
    s_cbranch_scc1 L_retry_34
L_join_35:
    v_lshlrev_b32 v4, 21, v128
    v_lshlrev_b32 v5, 21, v132
    v_ashrrev_i32 v128, 10, v128
    v_ashrrev_i32 v129, 10, v129
    v_ashrrev_i32 v130, 10, v130
    v_ashrrev_i32 v131, 10, v131
    v_ashrrev_i32 v132, 10, v132
    v_ashrrev_i32 v133, 10, v133
    v_ashrrev_i32 v134, 10, v134
    v_ashrrev_i32 v135, 10, v135
    v_and_b32 v4, 0x7f800000, v4
    v_and_b32 v5, 0x7f800000, v5
    v_cvt_f32_i32 v128, v128
    v_cvt_f32_i32 v129, v129
    v_cvt_f32_i32 v130, v130
    v_cvt_f32_i32 v131, v131
    v_cvt_f32_i32 v132, v132
    v_cvt_f32_i32 v133, v133
    v_cvt_f32_i32 v134, v134
    v_cvt_f32_i32 v135, v135
    v_subrev_u32 v4, 0xa000000, v4
    v_subrev_u32 v5, 0xa000000, v5
    v_mul_f32 v128, v4, v128
    v_mul_f32 v129, v4, v129
    v_mul_f32 v130, v4, v130
    v_mul_f32 v131, v4, v131
    v_fmac_f32 v128, v5, v132
    v_fmac_f32 v129, v5, v133
    v_fmac_f32 v130, v5, v134
    v_fmac_f32 v131, v5, v135
    v_mov_b32 v132, v128
    v_mov_b32 v133, v129
    v_mov_b32 v134, v130
    v_mov_b32 v135, v131
    v_permlane32_swap_b32 v128, v132
    v_permlane32_swap_b32 v129, v133
    v_permlane32_swap_b32 v130, v134
    v_permlane32_swap_b32 v131, v135
    v_add_f32 v128, v128, v132
    v_add_f32 v129, v129, v133
    v_add_f32 v130, v130, v134
    v_add_f32 v131, v131, v135
    v_cvt_pk_bf16_f32 v4, v128, v129
    v_cvt_pk_bf16_f32 v5, v130, v131
    s_mov_b32 exec_hi, 0
    ds_write_b64 v30, v[4:5] offset:1024
    v_mov_b32 v12, 0x100
    s_mov_b64 exec, 1
    ds_add_u32 v10, v12
    s_mov_b64 exec, -1
    s_sub_u32 s7, s46, s59
    s_and_b32 s7, s7, 7
    s_lshl_b32 s7, s7, 2
    s_add_i32 s7, s7, s39
    s_add_i32 s58, s7, 84
L_w_36:
    ds_read_b64 v[2:3], v10
    s_waitcnt lgkmcnt(0)
    v_readfirstlane_b32 s6, v2
    v_readfirstlane_b32 s7, v3
    s_cmp_ge_i32 s7, s58
    s_cselect_b32 s6, s6, 0
    s_bitcmp1_b32 s6, 11
    s_cbranch_scc1 L_wd_37
    s_sub_i32 s37, s37, 1
    s_cmp_gt_i32 s37, 0
    s_cbranch_scc1 L_w_36
L_wd_37:
    ds_read_b128 v[32:35], v18
    ds_read_b128 v[64:67], v16 offset:0
    ds_read_b128 v[36:39], v19
    ds_read_b128 v[68:71], v16 offset:64
    ds_read_b128 v[40:43], v20
    ds_read_b128 v[72:75], v16 offset:128
    ds_read_b128 v[44:47], v21
    ds_read_b128 v[76:79], v16 offset:192
    s_waitcnt lgkmcnt(6)
    v_mfma_f32_16x16x32_bf16 v[96:99], v[32:35], v[64:67], 0
    s_waitcnt lgkmcnt(4)
    v_mfma_f32_16x16x32_bf16 v[96:99], v[36:39], v[68:71], v[96:99]
    s_waitcnt lgkmcnt(2)
    v_mfma_f32_16x16x32_bf16 v[96:99], v[40:43], v[72:75], v[96:99]
    s_waitcnt lgkmcnt(0)
    v_mfma_f32_16x16x32_bf16 v[96:99], v[44:47], v[76:79], v[96:99]
    s_nop 7
    v_cvt_pk_bf16_f32 v104, v96, v97
    v_cvt_pk_bf16_f32 v105, v98, v99
    v_lshlrev_b32 v106, 16, v104
    v_and_b32 v107, 0xffff0000, v104
    v_lshlrev_b32 v108, 16, v105
    v_and_b32 v109, 0xffff0000, v105
    v_mul_f32 v106, 0x3db504f3, v106
    v_mul_f32 v107, 0x3db504f3, v107
    v_mul_f32 v108, 0x3db504f3, v108
    v_mul_f32 v109, 0x3db504f3, v109
    v_cvt_pk_bf16_f32 v104, v106, v107
    v_cvt_pk_bf16_f32 v105, v108, v109
    v_lshlrev_b32 v106, 16, v104
    v_and_b32 v107, 0xffff0000, v104
    v_lshlrev_b32 v108, 16, v105
    v_and_b32 v109, 0xffff0000, v105
    v_mul_f32 v106, 0x3fb8aa3b, v106
    v_mul_f32 v107, 0x3fb8aa3b, v107
    v_mul_f32 v108, 0x3fb8aa3b, v108
    v_mul_f32 v109, 0x3fb8aa3b, v109
    v_max_f32 v110, v106, v107
    v_max3_f32 v110, v108, v109, v110
    v_mov_b32 v112, v110
    s_nop 1
    v_permlane16_swap_b32 v110, v112
    v_max_f32 v110, v110, v112
    v_mov_b32 v112, v110
    s_nop 1
    v_permlane32_swap_b32 v110, v112
    v_max_f32 v110, v110, v112
    v_sub_f32 v106, v106, v110
    v_sub_f32 v107, v107, v110
    v_sub_f32 v108, v108, v110
    v_sub_f32 v109, v109, v110
    v_exp_f32 v106, v106
    v_exp_f32 v107, v107
    v_exp_f32 v108, v108
    v_exp_f32 v109, v109
    v_cvt_pk_bf16_f32 v104, v106, v107
    v_cvt_pk_bf16_f32 v105, v108, v109
    s_lshl_b32 s6, s46, 9
    v_add_u32 v4, s6, v29
    ds_write_b64 v4, v[104:105] offset:11776
    v_add_f32 v111, v106, v107
    v_add_f32 v112, v108, v109
    v_add_f32 v111, v111, v112
    v_mov_b32 v112, v111
    s_nop 1
    v_permlane16_swap_b32 v111, v112
    v_add_f32 v111, v111, v112
    v_mov_b32 v112, v111
    s_nop 1
    v_permlane32_swap_b32 v111, v112
    v_add_f32 v111, v111, v112
    s_lshl_b32 s6, s46, 3
    v_add_u32 v4, s6, v31
    s_mov_b64 exec, 0xff
    ds_write_b64 v4, v[110:111]
    v_mov_b32 v12, 0x1000
    s_mov_b64 exec, 1
    ds_add_u32 v10, v12
    s_mov_b64 exec, -1
    v_lshrrev_b32 v4, 5, v1
    s_lshl_b32 s6, s46, 1
    v_add_u32 v4, s6, v4
    v_and_b32 v5, 3, v4
    v_lshlrev_b32 v5, 24, v5
    v_add_u32 v18, 0x04020100, v5
    v_lshlrev_b32 v18, 1, v4
    v_and_b32 v5, 7, v1
    v_lshlrev_b32 v5, 8, v5
    v_lshl_add_u32 v5, v4, 4, v5
    v_add_u32 v19, 7552, v5
    v_and_b32 v4, 3, v1
    v_lshlrev_b32 v4, 3, v4
    v_lshlrev_b32 v4, v4, 15
    v_xor_b32 v20, 0x0c0c0c0c, v4
    v_and_b32 v4, 15, v1
    v_lshlrev_b32 v20, 1, v4
    v_lshrrev_b32 v5, 4, v1
    v_lshlrev_b32 v5, 2, v5
    v_lshl_add_u32 v4, v4, 4, v5
    s_mul_i32 s6, s46, 272
    s_add_u32 s6, s6, 5376
    v_add_u32 v21, s6, v4
    s_lshl_b32 s6, s46, 8
    s_add_u32 s6, s6, 7552
    v_add_u32 v17, s6, v28
    s_add_i32 s58, s39, 120
L_w_38:
    ds_read_b64 v[2:3], v10
    s_waitcnt lgkmcnt(0)
    v_readfirstlane_b32 s6, v2
    v_readfirstlane_b32 s7, v3
    s_cmp_ge_i32 s7, s58
    s_cselect_b32 s6, s6, 0
    s_bitcmp1_b32 s6, 15
    s_cbranch_scc1 L_wd_39
    s_sub_i32 s37, s37, 1
    s_cmp_gt_i32 s37, 0
    s_cbranch_scc1 L_w_38
L_wd_39:
    s_cmp_eq_u32 s46, 7
    s_cbranch_scc1 L_nh_40
    global_load_dwordx4 v[144:147], v28, s[70:71] offset:0 sc1
L_nh_40:
    ds_read_b128 v[152:155], v31 offset:0
    ds_read_b128 v[156:159], v31 offset:16
    ds_read_b128 v[160:163], v31 offset:32
    ds_read_b128 v[60:63], v31 offset:48
    v_add_u32 v4, 11776, v29
    ds_read2st64_b64 v[64:67], v4 offset0:0 offset1:1
    ds_read2st64_b64 v[68:71], v4 offset0:2 offset1:3
    ds_read2st64_b64 v[72:75], v4 offset0:4 offset1:5
    ds_read2st64_b64 v[76:79], v4 offset0:6 offset1:7
    s_waitcnt lgkmcnt(4)
    v_max3_f32 v5, v152, v154, v156
    v_max3_f32 v5, v158, v160, v5
    v_max3_f32 v5, v162, v60, v5
    v_max_f32 v5, v62, v5
    v_sub_f32 v152, v152, v5
    v_sub_f32 v154, v154, v5
    v_sub_f32 v156, v156, v5
    v_sub_f32 v158, v158, v5
    v_sub_f32 v160, v160, v5
    v_sub_f32 v162, v162, v5
    v_sub_f32 v60, v60, v5
    v_sub_f32 v62, v62, v5
    v_exp_f32 v152, v152
    v_exp_f32 v154, v154
    v_exp_f32 v156, v156
    v_exp_f32 v158, v158
    v_exp_f32 v160, v160
    v_exp_f32 v162, v162
    v_exp_f32 v60, v60
    v_exp_f32 v62, v62
    v_mul_f32 v6, v152, v153
    v_fmac_f32 v6, v154, v155
    v_fmac_f32 v6, v156, v157
    v_fmac_f32 v6, v158, v159
    v_fmac_f32 v6, v160, v161
    v_fmac_f32 v6, v162, v163
    v_fmac_f32 v6, v60, v61
    v_fmac_f32 v6, v62, v63
    v_rcp_f32 v7, v6
    v_log_f32 v6, v6
    v_mul_f32 v152, v152, v7
    v_mul_f32 v154, v154, v7
    v_mul_f32 v156, v156, v7
    v_mul_f32 v158, v158, v7
    v_mul_f32 v160, v160, v7
    v_mul_f32 v162, v162, v7
    v_mul_f32 v60, v60, v7
    v_mul_f32 v62, v62, v7
    v_add_f32 v58, v5, v6
    v_mov_b32 v59, v11
    s_add_i32 s58, s39, 144
L_w_41:
    ds_read_b64 v[2:3], v10
    s_waitcnt lgkmcnt(0)
    v_readfirstlane_b32 s6, v2
    v_readfirstlane_b32 s7, v3
    s_cmp_ge_i32 s7, s58
    s_cselect_b32 s6, s6, 0
    s_bitcmp1_b32 s6, 31
    s_cbranch_scc1 L_wd_42
    s_sub_i32 s37, s37, 1
    s_cmp_gt_i32 s37, 0
    s_cbranch_scc1 L_w_41
L_wd_42:
    ds_read_b64_tr_b16 v[32:33], v22 offset:0
    ds_read_b64_tr_b16 v[34:35], v22 offset:4096
    ds_read_b64_tr_b16 v[36:37], v22 offset:8192
    ds_read_b64_tr_b16 v[38:39], v22 offset:12288
    ds_read_b64_tr_b16 v[40:41], v22 offset:16384
    ds_read_b64_tr_b16 v[42:43], v22 offset:20480
    ds_read_b64_tr_b16 v[44:45], v22 offset:24576
    ds_read_b64_tr_b16 v[46:47], v22 offset:28672
    s_waitcnt lgkmcnt(7)
    v_mfma_f32_16x16x16_bf16 v[96:99], v[32:33], v[64:65], 0
    s_waitcnt lgkmcnt(6)
    v_mfma_f32_16x16x16_bf16 v[100:103], v[34:35], v[66:67], 0
    s_waitcnt lgkmcnt(5)
    v_mfma_f32_16x16x16_bf16 v[104:107], v[36:37], v[68:69], 0
    s_waitcnt lgkmcnt(4)
    v_mfma_f32_16x16x16_bf16 v[108:111], v[38:39], v[70:71], 0
    s_waitcnt lgkmcnt(3)
    v_mfma_f32_16x16x16_bf16 v[112:115], v[40:41], v[72:73], 0
    s_waitcnt lgkmcnt(2)
    v_mfma_f32_16x16x16_bf16 v[116:119], v[42:43], v[74:75], 0
    s_waitcnt lgkmcnt(1)
    v_mfma_f32_16x16x16_bf16 v[120:123], v[44:45], v[76:77], 0
    s_waitcnt lgkmcnt(0)
    v_mfma_f32_16x16x16_bf16 v[124:127], v[46:47], v[78:79], 0
    v_mul_f32 v48, v152, v96
    v_mul_f32 v49, v152, v97
    v_mul_f32 v50, v152, v98
    v_mul_f32 v51, v152, v99
    v_fmac_f32 v48, v154, v100
    v_fmac_f32 v49, v154, v101
    v_fmac_f32 v50, v154, v102
    v_fmac_f32 v51, v154, v103
    v_fmac_f32 v48, v156, v104
    v_fmac_f32 v49, v156, v105
    v_fmac_f32 v50, v156, v106
    v_fmac_f32 v51, v156, v107
    v_fmac_f32 v48, v158, v108
    v_fmac_f32 v49, v158, v109
    v_fmac_f32 v50, v158, v110
    v_fmac_f32 v51, v158, v111
    v_fmac_f32 v48, v160, v112
    v_fmac_f32 v49, v160, v113
    v_fmac_f32 v50, v160, v114
    v_fmac_f32 v51, v160, v115
    v_fmac_f32 v48, v162, v116
    v_fmac_f32 v49, v162, v117
    v_fmac_f32 v50, v162, v118
    v_fmac_f32 v51, v162, v119
    v_fmac_f32 v48, v60, v120
    v_fmac_f32 v49, v60, v121
    v_fmac_f32 v50, v60, v122
    v_fmac_f32 v51, v60, v123
    v_fmac_f32 v48, v62, v124
    v_fmac_f32 v49, v62, v125
    v_fmac_f32 v50, v62, v126
    v_fmac_f32 v51, v62, v127
    v_permlane16_swap_b32 v48, v52
    v_permlane16_swap_b32 v49, v53
    v_permlane16_swap_b32 v50, v54
    v_permlane16_swap_b32 v51, v55
    v_max3_f32 v4, |v48|, |v49|, |v50|
    v_max3_f32 v5, |v51|, |v52|, |v53|
    v_max3_f32 v4, |v54|, |v55|, v4
    v_max_f32 v4, v4, v5
    v_mul_f32 v4, 0x3f802000, v4
    v_max_f32 v4, 0x08000000, v4
    v_and_b32 v5, 0x7f800000, v4
    v_sub_u32 v5, 0x83800000, v5
    v_lshrrev_b32 v6, 21, v4
    v_lshrrev_b32 v4, v18, v58
    v_bfi_b32 v6, 3, v4, v6
    v_pk_fma_f32 v[48:49], v[48:49], v[4:5], s[94:95] op_sel:[0,1,0] op_sel_hi:[1,1,0]
    v_pk_fma_f32 v[50:51], v[50:51], v[4:5], s[94:95] op_sel:[0,1,0] op_sel_hi:[1,1,0]
    v_pk_fma_f32 v[52:53], v[52:53], v[4:5], s[94:95] op_sel:[0,1,0] op_sel_hi:[1,1,0]
    v_pk_fma_f32 v[54:55], v[54:55], v[4:5], s[94:95] op_sel:[0,1,0] op_sel_hi:[1,1,0]
    v_lshlrev_b32 v48, 10, v48
    v_lshlrev_b32 v50, 10, v50
    v_lshlrev_b32 v52, 10, v52
    v_lshlrev_b32 v54, 10, v54
    v_lshl_or_b32 v49, v49, 21, v6
    v_lshl_or_b32 v51, v51, 21, s8
    v_lshl_or_b32 v53, v53, 21, s9
    v_lshl_or_b32 v55, v55, 21, s10
    v_bfi_b32 v96, s17, v48, v49
    v_bfi_b32 v97, s17, v50, v51
    v_bfi_b32 v98, s17, v52, v53
    v_bfi_b32 v99, s17, v54, v55
    s_mov_b32 exec_lo, 0xff
    s_mov_b32 exec_hi, 0xff
    ds_write_b128 v19, v[96:99]
    v_mov_b32 v12, -1
    s_mov_b64 exec, 1
    ds_add_u32 v10, v12
    s_mov_b64 exec, -1
L_ow_43:
    ds_read_b32 v2, v10
    s_waitcnt lgkmcnt(0)
    v_readfirstlane_b32 s6, v2
    s_and_b32 s6, s6, 15
    s_cbranch_scc0 L_owd_44
    s_sub_i32 s37, s37, 1
    s_cmp_gt_i32 s37, 0
    s_cbranch_scc1 L_ow_43
L_owd_44:
    s_mov_b64 exec, 0xffff
    ds_read_b128 v[96:99], v17
    s_waitcnt lgkmcnt(0)
    global_store_dwordx4 v28, v[96:99], s[74:75] sc1
    s_mov_b64 exec, -1
    s_cmp_eq_u32 s46, 7
    s_cbranch_scc1 L_nh_45
    s_waitcnt vmcnt(1)
    v_xor_b32 v5, s8, v145
    v_xor_b32 v6, s9, v146
    v_xor_b32 v7, s10, v147
    v_or3_b32 v6, v5, v6, v7
    v_and_b32 v6, 0x3ff, v6
    v_cmp_ne_u32 s[84:85], 0, v6
    s_or_b64 vcc, s[84:85], s[84:85]
    s_cbranch_scc1 L_retry_46
L_join_47:
    v_lshlrev_b32 v7, 21, v144
    v_bfe_i32 v96, v144, 10, 11
    v_ashrrev_i32 v97, 21, v144
    v_bfe_i32 v98, v145, 10, 11
    v_ashrrev_i32 v99, 21, v145
    v_bfe_i32 v100, v146, 10, 11
    v_ashrrev_i32 v101, 21, v146
    v_bfe_i32 v102, v147, 10, 11
    v_ashrrev_i32 v103, 21, v147
    v_and_b32 v7, 0x7f800000, v7
    v_subrev_u32 v7, 0x4800000, v7
    v_cvt_f32_i32 v96, v96
    v_cvt_f32_i32 v97, v97
    v_cvt_f32_i32 v98, v98
    v_cvt_f32_i32 v99, v99
    v_cvt_f32_i32 v100, v100
    v_cvt_f32_i32 v101, v101
    v_cvt_f32_i32 v102, v102
    v_cvt_f32_i32 v103, v103
    v_mul_f32 v96, v7, v96
    v_mul_f32 v97, v7, v97
    v_mul_f32 v98, v7, v98
    v_mul_f32 v99, v7, v99
    v_mul_f32 v100, v7, v100
    v_mul_f32 v101, v7, v101
    v_mul_f32 v102, v7, v102
    v_mul_f32 v103, v7, v103
    v_permlane32_swap_b32 v96, v100
    v_permlane32_swap_b32 v97, v101
    v_permlane32_swap_b32 v98, v102
    v_permlane32_swap_b32 v99, v103
    v_add_f32 v96, v96, v100
    v_add_f32 v97, v97, v101
    v_add_f32 v98, v98, v102
    v_add_f32 v99, v99, v103
    s_nop 0
    v_permlane16_swap_b32 v96, v98
    v_permlane16_swap_b32 v97, v99
    v_add_f32 v96, v96, v98
    v_add_f32 v97, v97, v99
    v_cvt_pk_bf16_f32 v4, v96, v97
    v_lshlrev_b32 v100, 16, v8
    v_and_b32 v101, 0xffff0000, v8
    v_lshlrev_b32 v96, 16, v4
    v_and_b32 v97, 0xffff0000, v4
    v_add_f32 v96, v96, v100
    v_add_f32 v97, v97, v101
    v_cvt_pk_bf16_f32 v4, v96, v97
    v_lshlrev_b32 v96, 16, v4
    v_and_b32 v97, 0xffff0000, v4
    v_mul_f32 v100, v96, v96
    v_mul_f32 v101, v97, v97
    v_mul_f32 v100, 0x3d372713, v100
    v_mul_f32 v101, 0x3d372713, v101
    v_fma_f32 v100, v100, v96, v96
    v_fma_f32 v101, v101, v97, v97
    v_mul_f32 v100, 0xc0135761, v100
    v_mul_f32 v101, 0xc0135761, v101
    v_exp_f32 v100, v100
    v_exp_f32 v101, v101
    v_add_f32 v100, 1.0, v100
    v_add_f32 v101, 1.0, v101
    v_rcp_f32 v100, v100
    v_rcp_f32 v101, v101
    v_mul_f32 v96, v96, v100
    v_mul_f32 v97, v97, v101
    v_cvt_pk_bf16_f32 v4, v96, v97
    ds_write_b32 v165, v4 offset:3200
L_nh_45:
    v_mov_b32 v12, 0x10000
    s_mov_b64 exec, 1
    ds_add_u32 v10, v12
    s_mov_b64 exec, -1
    s_add_i32 s58, s39, 172
L_w_48:
    ds_read_b64 v[2:3], v10
    s_waitcnt lgkmcnt(0)
    v_readfirstlane_b32 s6, v2
    v_readfirstlane_b32 s7, v3
    s_cmp_ge_i32 s7, s58
    s_cselect_b32 s6, s6, 0
    s_bitcmp1_b32 s6, 19
    s_cbranch_scc1 L_wd_49
    s_sub_i32 s37, s37, 1
    s_cmp_gt_i32 s37, 0
    s_cbranch_scc1 L_w_48
L_wd_49:
    ds_read2_b64 v[64:67], v14 offset0:0 offset1:4
    ds_read_b64_tr_b16 v[32:33], v23 offset:0
    ds_read_b64_tr_b16 v[34:35], v23 offset:4096
    ds_read2_b64 v[68:71], v14 offset0:8 offset1:12
    ds_read_b64_tr_b16 v[36:37], v23 offset:8192
    ds_read_b64_tr_b16 v[38:39], v23 offset:12288
    ds_read2_b64 v[72:75], v14 offset0:16 offset1:20
    ds_read_b64_tr_b16 v[40:41], v23 offset:16384
    ds_read_b64_tr_b16 v[42:43], v23 offset:20480
    ds_read_b64 v[76:77], v14 offset:192
    ds_read_b64_tr_b16 v[44:45], v23 offset:24576
    s_waitcnt lgkmcnt(8)
    v_mfma_f32_16x16x32_bf16 v[96:99], v[32:35], v[64:67], 0
    s_waitcnt lgkmcnt(5)
    v_mfma_f32_16x16x32_bf16 v[96:99], v[36:39], v[68:71], v[96:99]
    s_waitcnt lgkmcnt(2)
    v_mfma_f32_16x16x32_bf16 v[96:99], v[40:43], v[72:75], v[96:99]
    s_waitcnt lgkmcnt(0)
    v_mfma_f32_16x16x16_bf16 v[100:103], v[44:45], v[76:77], 0
    s_nop 7
    v_add_f32 v96, v96, v100
    v_add_f32 v97, v97, v101
    v_add_f32 v98, v98, v102
    v_add_f32 v99, v99, v103
    v_permlane16_swap_b32 v96, v100
    v_permlane16_swap_b32 v97, v101
    v_permlane16_swap_b32 v98, v102
    v_permlane16_swap_b32 v99, v103
    v_max3_f32 v4, |v96|, |v97|, |v98|
    v_max3_f32 v5, |v99|, |v100|, |v101|
    v_max3_f32 v4, |v102|, |v103|, v4
    v_max_f32 v4, v4, v5
    v_mul_f32 v4, 0x3f802000, v4
    v_max_f32 v4, 0x08000000, v4
    v_and_b32 v5, 0x7f800000, v4
    v_sub_u32 v5, 0x83800000, v5
    v_lshrrev_b32 v6, 21, v4
    v_pk_fma_f32 v[96:97], v[96:97], v[4:5], s[94:95] op_sel:[0,1,0] op_sel_hi:[1,1,0]
    v_pk_fma_f32 v[98:99], v[98:99], v[4:5], s[94:95] op_sel:[0,1,0] op_sel_hi:[1,1,0]
    v_pk_fma_f32 v[100:101], v[100:101], v[4:5], s[94:95] op_sel:[0,1,0] op_sel_hi:[1,1,0]
    v_pk_fma_f32 v[102:103], v[102:103], v[4:5], s[94:95] op_sel:[0,1,0] op_sel_hi:[1,1,0]
    v_lshlrev_b32 v96, 10, v96
    v_lshlrev_b32 v98, 10, v98
    v_lshlrev_b32 v100, 10, v100
    v_lshlrev_b32 v102, 10, v102
    v_lshl_or_b32 v97, v97, 21, v6
    v_lshl_or_b32 v99, v99, 21, s8
    v_lshl_or_b32 v101, v101, 21, s9
    v_lshl_or_b32 v103, v103, 21, s10
    v_bfi_b32 v104, s17, v96, v97
    v_bfi_b32 v105, s17, v98, v99
    v_bfi_b32 v106, s17, v100, v101
    v_bfi_b32 v107, s17, v102, v103
    s_mov_b32 exec_lo, 0xff
    s_mov_b32 exec_hi, 0xff
    global_store_dwordx4 v166, v[104:107], s[78:79] sc1
    s_mov_b64 exec, -1
    s_add_i32 s58, s39, 192
L_w_50:
    ds_read_b64 v[2:3], v10
    s_waitcnt lgkmcnt(0)
    v_readfirstlane_b32 s6, v2
    v_readfirstlane_b32 s7, v3
    s_cmp_ge_i32 s7, s58
    s_cselect_b32 s6, s6, 0
    s_bitcmp1_b32 s6, 31
    s_cbranch_scc1 L_wd_51
    s_sub_i32 s37, s37, 1
    s_cmp_gt_i32 s37, 0
    s_cbranch_scc1 L_w_50
L_wd_51:
    global_load_dwordx4 v[128:131], v28, s[80:81] offset:0 sc1
    global_load_dwordx4 v[132:135], v28, s[80:81] offset:1024 sc1
    s_waitcnt vmcnt(0)
    v_xor_b32 v5, s8, v129
    v_xor_b32 v6, s9, v130
    v_xor_b32 v7, s10, v131
    v_or3_b32 v6, v5, v6, v7
    v_and_b32 v6, 0x3ff, v6
    v_cmp_ne_u32 s[84:85], 0, v6
    v_xor_b32 v5, s8, v133
    v_xor_b32 v6, s9, v134
    v_xor_b32 v7, s10, v135
    v_or3_b32 v6, v5, v6, v7
    v_and_b32 v6, 0x3ff, v6
    v_cmp_ne_u32 s[86:87], 0, v6
    s_or_b64 vcc, s[84:85], s[86:87]
    s_cbranch_scc1 L_retry_52
L_join_53:
    v_and_b32 v104, 3, v128
    v_and_b32 v105, 3, v132
    v_lshlrev_b32 v104, v20, v104
    v_lshlrev_b32 v105, v20, v105
    s_nop 0
    v_or_b32_dpp v104, v104, v104 quad_perm:[1,0,3,2] row_mask:0xf bank_mask:0xf
    v_or_b32_dpp v105, v105, v105 quad_perm:[1,0,3,2] row_mask:0xf bank_mask:0xf
    s_nop 0
    v_or_b32_dpp v104, v104, v104 quad_perm:[2,3,0,1] row_mask:0xf bank_mask:0xf
    v_or_b32_dpp v105, v105, v105 quad_perm:[2,3,0,1] row_mask:0xf bank_mask:0xf
    s_nop 0
    v_or_b32_dpp v104, v104, v104 row_half_mirror row_mask:0xf bank_mask:0xf
    v_or_b32_dpp v105, v105, v105 row_half_mirror row_mask:0xf bank_mask:0xf
    s_nop 0
    v_or_b32_dpp v104, v104, v104 row_mirror row_mask:0xf bank_mask:0xf
    v_or_b32_dpp v105, v105, v105 row_mirror row_mask:0xf bank_mask:0xf
    v_max_f32 v5, v104, v105
    v_mov_b32 v6, v5
    s_nop 1
    v_permlane16_swap_b32 v5, v6
    v_max_f32 v5, v5, v6
    v_mov_b32 v6, v5
    s_nop 1
    v_permlane32_swap_b32 v5, v6
    v_max_f32 v5, v5, v6
    v_sub_f32 v104, v104, v5
    v_sub_f32 v105, v105, v5
    v_exp_f32 v104, v104
    v_exp_f32 v105, v105
    v_bfe_i32 v32, v128, 10, 11
    v_bfe_i32 v33, v128, 21, 11
    v_bfe_i32 v34, v129, 10, 11
    v_bfe_i32 v35, v129, 21, 11
    v_bfe_i32 v36, v130, 10, 11
    v_bfe_i32 v37, v130, 21, 11
    v_bfe_i32 v38, v131, 10, 11
    v_bfe_i32 v39, v131, 21, 11
    v_bfe_i32 v40, v132, 10, 11
    v_bfe_i32 v41, v132, 21, 11
    v_bfe_i32 v42, v133, 10, 11
    v_bfe_i32 v43, v133, 21, 11
    v_bfe_i32 v44, v134, 10, 11
    v_bfe_i32 v45, v134, 21, 11
    v_bfe_i32 v46, v135, 10, 11
    v_bfe_i32 v47, v135, 21, 11
    v_bfe_u32 v106, v128, 2, 8
    v_bfe_u32 v107, v132, 2, 8
    v_subrev_u32 v106, 136, v106
    v_subrev_u32 v107, 136, v107
    v_add_f32 v5, v104, v105
    v_ldexp_f32 v104, v104, v106
    v_ldexp_f32 v105, v105, v107
    v_cvt_f32_i32 v32, v32
    v_cvt_f32_i32 v33, v33
    v_cvt_f32_i32 v34, v34
    v_cvt_f32_i32 v35, v35
    v_cvt_f32_i32 v36, v36
    v_cvt_f32_i32 v37, v37
    v_cvt_f32_i32 v38, v38
    v_cvt_f32_i32 v39, v39
    v_cvt_f32_i32 v40, v40
    v_cvt_f32_i32 v41, v41
    v_cvt_f32_i32 v42, v42
    v_cvt_f32_i32 v43, v43
    v_cvt_f32_i32 v44, v44
    v_cvt_f32_i32 v45, v45
    v_cvt_f32_i32 v46, v46
    v_cvt_f32_i32 v47, v47
    v_mov_b32 v6, v5
    s_nop 1
    v_permlane16_swap_b32 v5, v6
    v_add_f32 v5, v5, v6
    v_mov_b32 v6, v5
    s_nop 1
    v_permlane32_swap_b32 v5, v6
    v_add_f32 v5, v5, v6
    v_rcp_f32 v5, v5
    v_pk_mul_f32 v[32:33], v[32:33], v[104:105] op_sel_hi:[1,0]
    v_pk_mul_f32 v[34:35], v[34:35], v[104:105] op_sel_hi:[1,0]
    v_pk_mul_f32 v[36:37], v[36:37], v[104:105] op_sel_hi:[1,0]
    v_pk_mul_f32 v[38:39], v[38:39], v[104:105] op_sel_hi:[1,0]
    v_pk_fma_f32 v[32:33], v[40:41], v[104:105], v[32:33] op_sel:[0,1,0] op_sel_hi:[1,1,1]
    v_pk_fma_f32 v[34:35], v[42:43], v[104:105], v[34:35] op_sel:[0,1,0] op_sel_hi:[1,1,1]
    v_pk_fma_f32 v[36:37], v[44:45], v[104:105], v[36:37] op_sel:[0,1,0] op_sel_hi:[1,1,1]
    v_pk_fma_f32 v[38:39], v[46:47], v[104:105], v[38:39] op_sel:[0,1,0] op_sel_hi:[1,1,1]
    s_nop 0
    v_permlane32_swap_b32 v32, v36
    v_permlane32_swap_b32 v33, v37
    v_permlane32_swap_b32 v34, v38
    v_permlane32_swap_b32 v35, v39
    v_pk_add_f32 v[32:33], v[32:33], v[36:37]
    v_pk_add_f32 v[34:35], v[34:35], v[38:39]
    s_nop 1
    v_permlane16_swap_b32 v32, v34
    v_permlane16_swap_b32 v33, v35
    v_pk_add_f32 v[32:33], v[32:33], v[34:35]
    v_mul_f32 v32, v32, v5
    v_mul_f32 v33, v33, v5
    v_cvt_pk_bf16_f32 v4, v32, v33
    ds_write_b32 v21, v4
    v_mov_b32 v12, 0x100000
    s_mov_b64 exec, 1
    ds_add_u32 v10, v12
    s_mov_b64 exec, -1
    s_add_i32 s58, s39, 204
L_w_54:
    ds_read_b64 v[2:3], v10
    s_waitcnt lgkmcnt(0)
    v_readfirstlane_b32 s6, v2
    v_readfirstlane_b32 s7, v3
    s_cmp_ge_i32 s7, s58
    s_cselect_b32 s6, s6, 0
    s_bitcmp1_b32 s6, 23
    s_cbranch_scc1 L_wd_55
    s_sub_i32 s37, s37, 1
    s_cmp_gt_i32 s37, 0
    s_cbranch_scc1 L_w_54
L_wd_55:
    ds_read2_b64 v[64:67], v15 offset0:0 offset1:4
    ds_read_b64_tr_b16 v[32:33], v23 offset:32768
    ds_read_b64_tr_b16 v[34:35], v23 offset:36864
    ds_read2_b64 v[68:71], v15 offset0:8 offset1:12
    ds_read_b64_tr_b16 v[36:37], v23 offset:40960
    ds_read_b64_tr_b16 v[38:39], v23 offset:45056
    ds_read2_b64 v[72:75], v15 offset0:16 offset1:20
    ds_read_b64_tr_b16 v[40:41], v23 offset:49152
    ds_read_b64_tr_b16 v[42:43], v23 offset:53248
    ds_read2_b64 v[76:79], v15 offset0:24 offset1:28
    ds_read_b64_tr_b16 v[44:45], v23 offset:57344
    ds_read_b64_tr_b16 v[46:47], v23 offset:61440
    s_waitcnt lgkmcnt(9)
    v_mfma_f32_16x16x32_bf16 v[96:99], v[32:35], v[64:67], 0
    s_waitcnt lgkmcnt(6)
    v_mfma_f32_16x16x32_bf16 v[96:99], v[36:39], v[68:71], v[96:99]
    s_waitcnt lgkmcnt(3)
    v_mfma_f32_16x16x32_bf16 v[96:99], v[40:43], v[72:75], v[96:99]
    s_waitcnt lgkmcnt(0)
    v_mfma_f32_16x16x32_bf16 v[96:99], v[44:47], v[76:79], v[96:99]
    s_nop 7
    v_permlane16_swap_b32 v96, v100
    v_permlane16_swap_b32 v97, v101
    v_permlane16_swap_b32 v98, v102
    v_permlane16_swap_b32 v99, v103
    v_max3_f32 v4, |v96|, |v97|, |v98|
    v_max3_f32 v5, |v99|, |v100|, |v101|
    v_max3_f32 v4, |v102|, |v103|, v4
    v_max_f32 v4, v4, v5
    v_mul_f32 v4, 0x3f802000, v4
    v_max_f32 v4, 0x08000000, v4
    v_and_b32 v5, 0x7f800000, v4
    v_sub_u32 v5, 0x83800000, v5
    v_lshrrev_b32 v6, 21, v4
    v_pk_fma_f32 v[96:97], v[96:97], v[4:5], s[94:95] op_sel:[0,1,0] op_sel_hi:[1,1,0]
    v_pk_fma_f32 v[98:99], v[98:99], v[4:5], s[94:95] op_sel:[0,1,0] op_sel_hi:[1,1,0]
    v_pk_fma_f32 v[100:101], v[100:101], v[4:5], s[94:95] op_sel:[0,1,0] op_sel_hi:[1,1,0]
    v_pk_fma_f32 v[102:103], v[102:103], v[4:5], s[94:95] op_sel:[0,1,0] op_sel_hi:[1,1,0]
    v_lshlrev_b32 v96, 10, v96
    v_lshlrev_b32 v98, 10, v98
    v_lshlrev_b32 v100, 10, v100
    v_lshlrev_b32 v102, 10, v102
    v_lshl_or_b32 v97, v97, 21, v6
    v_lshl_or_b32 v99, v99, 21, s8
    v_lshl_or_b32 v101, v101, 21, s9
    v_lshl_or_b32 v103, v103, 21, s10
    v_bfi_b32 v104, s17, v96, v97
    v_bfi_b32 v105, s17, v98, v99
    v_bfi_b32 v106, s17, v100, v101
    v_bfi_b32 v107, s17, v102, v103
    s_mov_b32 exec_lo, 0xff
    s_mov_b32 exec_hi, 0xff
    global_store_dwordx4 v166, v[104:107], s[76:77] sc1
    v_mov_b32 v12, 0x1000000
    s_mov_b64 exec, 1
    ds_add_u32 v10, v12
    s_mov_b64 exec, -1
    s_endpgm
L_retry_34:
    s_movk_i32 s38, 20000
L_loop_56:
    s_cmp_eq_u64 s[84:85], 0
    s_cbranch_scc1 L_sk_57
    global_load_dwordx4 v[128:131], v26, s[66:67] offset:0 sc1
L_sk_57:
    s_cmp_eq_u64 s[86:87], 0
    s_cbranch_scc1 L_sk_58
    global_load_dwordx4 v[132:135], v26, s[68:69] offset:0 sc1
L_sk_58:
    s_waitcnt vmcnt(0)
    v_xor_b32 v5, s8, v129
    v_xor_b32 v6, s9, v130
    v_xor_b32 v7, s10, v131
    v_or3_b32 v6, v5, v6, v7
    v_and_b32 v6, 0x3ff, v6
    v_cmp_ne_u32 s[84:85], 0, v6
    v_xor_b32 v5, s8, v133
    v_xor_b32 v6, s9, v134
    v_xor_b32 v7, s10, v135
    v_or3_b32 v6, v5, v6, v7
    v_and_b32 v6, 0x3ff, v6
    v_cmp_ne_u32 s[86:87], 0, v6
    s_or_b64 vcc, s[84:85], s[86:87]
    s_cbranch_scc0 L_join_35
    s_sub_u32 s38, s38, 1
    s_cmp_lg_u32 s38, 0
    s_cbranch_scc1 L_loop_56
    s_branch L_join_35
L_retry_46:
    s_movk_i32 s38, 20000
L_loop_59:
    s_cmp_eq_u64 s[84:85], 0
    s_cbranch_scc1 L_sk_60
    global_load_dwordx4 v[144:147], v28, s[70:71] offset:0 sc1
L_sk_60:
    s_waitcnt vmcnt(0)
    v_xor_b32 v5, s8, v145
    v_xor_b32 v6, s9, v146
    v_xor_b32 v7, s10, v147
    v_or3_b32 v6, v5, v6, v7
    v_and_b32 v6, 0x3ff, v6
    v_cmp_ne_u32 s[84:85], 0, v6
    s_or_b64 vcc, s[84:85], s[84:85]
    s_cbranch_scc0 L_join_47
    s_sub_u32 s38, s38, 1
    s_cmp_lg_u32 s38, 0
    s_cbranch_scc1 L_loop_59
    s_branch L_join_47
L_retry_52:
    s_movk_i32 s38, 20000
L_loop_61:
    s_cmp_eq_u64 s[84:85], 0
    s_cbranch_scc1 L_sk_62
    global_load_dwordx4 v[128:131], v28, s[80:81] offset:0 sc1
L_sk_62:
    s_cmp_eq_u64 s[86:87], 0
    s_cbranch_scc1 L_sk_63
    global_load_dwordx4 v[132:135], v28, s[80:81] offset:1024 sc1
L_sk_63:
    s_waitcnt vmcnt(0)
    v_xor_b32 v5, s8, v129
    v_xor_b32 v6, s9, v130
    v_xor_b32 v7, s10, v131
    v_or3_b32 v6, v5, v6, v7
    v_and_b32 v6, 0x3ff, v6
    v_cmp_ne_u32 s[84:85], 0, v6
    v_xor_b32 v5, s8, v133
    v_xor_b32 v6, s9, v134
    v_xor_b32 v7, s10, v135
    v_or3_b32 v6, v5, v6, v7
    v_and_b32 v6, 0x3ff, v6
    v_cmp_ne_u32 s[86:87], 0, v6
    s_or_b64 vcc, s[84:85], s[86:87]
    s_cbranch_scc0 L_join_53
    s_sub_u32 s38, s38, 1
    s_cmp_lg_u32 s38, 0
    s_cbranch_scc1 L_loop_61
    s_branch L_join_53
L_end:
s_endpgm
.fill 256, 4, 0xbf810000
.section .rodata,"a"
.p2align 6
.amdhsa_kernel recurrent_scan__sliding_block_cached__dense_activation_gelu__decode_kernel
  .amdhsa_next_free_vgpr 168
  .amdhsa_next_free_sgpr 102
  .amdhsa_accum_offset 168
  .amdhsa_group_segment_fixed_size 0
  .amdhsa_kernarg_size 104
  .amdhsa_user_sgpr_count 2
  .amdhsa_user_sgpr_kernarg_segment_ptr 1
  .amdhsa_system_sgpr_workgroup_id_x 1
.end_amdhsa_kernel
```
